```python
import torch

def _softmax(x, axis=-1):
    return torch.softmax(x, dim=axis)
def _gelu(x):
    return torch.nn.functional.gelu(x, approximate="tanh")
def _silu(x):
    return torch.nn.functional.silu(x)
def _sigmoid(x):
    return torch.sigmoid(x)
def _layernorm(x, axis=-1, eps=1e-5):
    m = x.mean(dim=axis, keepdim=True)
    v = x.var(dim=axis, keepdim=True, unbiased=False)
    return (x - m) / torch.sqrt(v + eps)
def _scatter_add(tgt, idx, src, axis=0):
    return tgt.clone().index_add_(axis, idx, src)
def _segment_sum(src, seg, n):
    out = torch.zeros((n,) + src.shape[1:], dtype=src.dtype)
    return out.index_add_(0, seg, src)
def _pad(x, pw):
    flat = tuple(v for pair in reversed(pw) for v in pair)
    return torch.nn.functional.pad(x, flat)

kernel_name = 'concat_heads__sliding_local_dilated__spectral_fnet__prompt'

def setup_inputs():

    _w = (lambda a: (lambda t: t.to(torch.bfloat16) if t.is_floating_point() else t)(torch.as_tensor(a)))
    def _A_setup():
        B, S, D = 1, 2048, 640
        return {
            "x": _w((lambda *s: torch.randn(*s, dtype=torch.bfloat16) * 0.2)(B, S, D)),
            "wqkv": _w((lambda *s: torch.randn(*s, dtype=torch.bfloat16) * 0.8)(D, 3 * D)),
            "wo": _w((lambda *s: torch.randn(*s, dtype=torch.bfloat16) * 0.2)(D, D)),
        }
    _A_in = _A_setup()

    def _B_setup():
        B, S, D = 1, 2048, 640
        ns = torch.arange(S)[:, None] * torch.arange(S)[None, :]
        nd = torch.arange(D)[:, None] * torch.arange(D)[None, :]
        Ws_re = torch.cos(-2.0 * torch.pi * ns / S).to(float)
        Ws_im = torch.sin(-2.0 * torch.pi * ns / S).to(float)
        Wd_re = torch.cos(-2.0 * torch.pi * nd / D).to(float)
        Wd_im = torch.sin(-2.0 * torch.pi * nd / D).to(float)
        return {
            "x": _w((lambda *s: torch.randn(*s, dtype=torch.bfloat16) * 0.05)(B, S, D)),
            "dft_seq_re": _w(Ws_re),
            "dft_seq_im": _w(Ws_im),
            "dft_hid_re": _w(Wd_re),
            "dft_hid_im": _w(Wd_im),
        }
    _B_in = _B_setup()

    return {
        "A_x": _A_in["x"],
        "A_wqkv": _A_in["wqkv"],
        "A_wo": _A_in["wo"],
        "B_x": _B_in["x"],
        "B_dft_seq_re": _B_in["dft_seq_re"],
        "B_dft_seq_im": _B_in["dft_seq_im"],
        "B_dft_hid_re": _B_in["dft_hid_re"],
        "B_dft_hid_im": _B_in["dft_hid_im"],
    }

def reference(A_x, A_wqkv, A_wo, B_x, B_dft_seq_re, B_dft_seq_im, B_dft_hid_re, B_dft_hid_im):
    def _A_ref(x, wqkv, wo):
        B, S, D = x.shape
        H = 32; Dh = D // H
        W, dil = 8, 2
        qkv = (lambda x, *d: x.permute(*d))((x @ wqkv).reshape(B, S, 3, H, Dh), 2, 0, 3, 1, 4)
        q, k, v = qkv[0], qkv[1], qkv[2]
        scale = Dh ** -0.5
        pos = torch.arange(S)
        off = torch.arange(W) * dil
        idx = pos[:, None] - off[None, :]
        mask = idx >= 0
        idx_c = torch.where(mask, idx, 0).reshape(-1)
        kg = k[:, :, idx_c, :].reshape(B, H, S, W, Dh)
        vg = v[:, :, idx_c, :].reshape(B, H, S, W, Dh)
        logits = torch.einsum("bhsd,bhswd->bhsw", q, kg) * scale
        logits = torch.where(mask[None, None, :, :], logits, -1e9)
        attn = _softmax(logits, axis=-1)
        o = torch.einsum("bhsw,bhswd->bhsd", attn, vg)
        return (lambda x, *d: x.permute(*d))(o, 0, 2, 1, 3).reshape(B, S, D) @ wo

    def _B_ref(x, dft_seq_re, dft_seq_im, dft_hid_re, dft_hid_im):
        a = torch.einsum("bsd,ed->bse", x, dft_hid_re)
        b = torch.einsum("bsd,ed->bse", x, dft_hid_im)
        y = torch.einsum("ts,bse->bte", dft_seq_re, a) - torch.einsum("ts,bse->bte", dft_seq_im, b)
        return y

    a = _A_ref(A_x, A_wqkv, A_wo)
    b = _B_ref(B_x, B_dft_seq_re, B_dft_seq_im, B_dft_hid_re, B_dft_hid_im)
    return torch.concatenate([a, b], axis=-1)
```

```asm
; @launch grid=(256,1,1) block=(512,1,1) lds=163840
.amdgcn_target "amdgcn-amd-amdhsa--gfx950"
.text
.globl concat_heads__sliding_local_dilated__spectral_fnet__prompt_kernel
.p2align 8
.type concat_heads__sliding_local_dilated__spectral_fnet__prompt_kernel,@function
concat_heads__sliding_local_dilated__spectral_fnet__prompt_kernel:
    s_cmp_ge_u32 s2, 256
    s_cbranch_scc1 L_exit
    s_load_dwordx4 s[4:7], s[0:1], 0
    s_load_dwordx4 s[8:11], s[0:1], 16
    s_load_dwordx4 s[12:15], s[0:1], 64
    s_load_dwordx2 s[16:17], s[0:1], 80
    v_lshrrev_b32 v1, 6, v0
    v_and_b32 v0, 63, v0
    v_readfirstlane_b32 s18, v1
    s_lshr_b32 s19, s2, 3
    v_lshlrev_b32 v250, 4, v0
    s_cmp_ge_u32 s19, 22
    s_cbranch_scc1 L_B
    s_and_b32 s72, s2, 7
    s_lshr_b32 s73, s72, 1
    s_mul_i32 s73, s73, 22
    s_add_u32 s73, s73, s19
    s_lshr_b32 s85, s73, 2
    s_and_b32 s75, s73, 3
    s_and_b32 s72, s72, 1
    s_lshl_b32 s72, s72, 2
    s_add_u32 s84, s72, s75
    s_cmp_lt_u32 s18, 4
    s_cbranch_scc1 L_comp
    s_setprio 3
    s_and_b32 s95, s18, 3
    s_lshl_b32 s74, s84, 2
    s_lshr_b32 s74, 0x43104310, s74
    s_and_b32 s74, s74, 15
    s_mul_i32 s73, s85, 1
    s_add_u32 s73, s73, s74
    s_mul_i32 s74, s73, 342
    s_lshr_b32 s74, s74, 11
    s_mul_i32 s74, s74, 6
    s_sub_u32 s73, s73, s74
    s_lshl_b32 s3, s73, 7
    s_lshl_b32 s72, s95, 2
    v_lshrrev_b32 v200, 4, v0
    v_add_u32 v200, s72, v200
    v_xor_b32 v200, v200, v0
    v_and_b32 v200, 7, v200
    v_lshlrev_b32 v200, 4, v200
    v_lshrrev_b32 v201, 3, v0
    v_mul_u32_u24 v201, 2560, v201
    v_add_u32 v4, v200, v201
    s_lshl_b32 s72, s95, 3
    s_or_b32 s72, s72, 0x80000
    s_mul_i32 s74, s85, 96
    s_sub_u32 s74, s74, 16
    s_bfe_u32 s73, 0x20100100, s72
    s_add_i32 s73, s73, s74
    s_max_i32 s73, s73, 0
    s_min_i32 s73, s73, 2033
    s_mul_i32 s96, s73, 1280
    s_bfe_u32 s73, 0x40302111, s72
    s_add_i32 s73, s73, s74
    s_max_i32 s73, s73, 0
    s_min_i32 s73, s73, 2033
    s_mul_i32 s97, s73, 1280
    s_bfe_u32 s73, 0x60504131, s72
    s_add_i32 s73, s73, s74
    s_max_i32 s73, s73, 0
    s_min_i32 s73, s73, 2033
    s_mul_i32 s98, s73, 1280
    s_bfe_u32 s73, 0x6151, s72
    s_add_i32 s73, s73, s74
    s_max_i32 s73, s73, 0
    s_min_i32 s73, s73, 2033
    s_mul_i32 s99, s73, 1280
    s_cmp_ge_u32 s95, 2
    s_cselect_b64 vcc, -1, 0
    s_lshl_b32 s94, s95, 10
    s_add_u32 s94, s94, 76800
    s_waitcnt lgkmcnt(0)
    s_mov_b32 s20, s4
    s_and_b32 s21, s5, 0xffff
    s_mov_b32 s22, 2621440
    s_mov_b32 s23, 0x20000
    s_mov_b32 s4, s3
    s_mov_b32 s3, s94
    s_cbranch_vccnz L_xs_12
    s_add_u32 m0, s3, 12288
    s_add_u32 s71, s99, s4
    buffer_load_dwordx4 v4, s[20:23], s71 offen lds
L_xs_12:
    s_add_u32 m0, s3, 0
    s_add_u32 s71, s96, s4
    buffer_load_dwordx4 v4, s[20:23], s71 offen lds
    s_add_u32 m0, s3, 4096
    s_add_u32 s71, s97, s4
    buffer_load_dwordx4 v4, s[20:23], s71 offen lds
    s_add_u32 m0, s3, 8192
    s_add_u32 s71, s98, s4
    buffer_load_dwordx4 v4, s[20:23], s71 offen lds
    s_add_u32 s3, s3, 14336
    s_cmp_ge_u32 s3, 119808
    s_cselect_b32 s71, 43008, 0
    s_sub_u32 s3, s3, s71
    s_mov_b32 s24, s6
    s_and_b32 s25, s7, 0xffff
    s_mov_b32 s26, 2457600
    s_mov_b32 s27, 0x20000
    s_mul_i32 s5, s95, 3840
    s_mov_b32 s86, -1
    s_mov_b32 s87, 0xffff
    s_mul_i32 s72, s95, 240
    s_mul_i32 s73, s84, 160
    s_movk_i32 s74, 6554
    s_movk_i32 s75, 2185
    v_add_u32 v200, s72, v0
    s_mul_i32 s70, s4, 1920
    v_mul_u32_u24 v201, s74, v200
    v_mul_u32_u24 v202, s75, v200
    v_lshrrev_b32 v201, 16, v201
    v_bfe_u32 v203, v202, 18, 2
    v_lshrrev_b32 v202, 20, v202
    v_mul_u32_u24 v201, 1120, v201
    v_mul_u32_u24 v203, 15360, v203
    v_mul_u32_u24 v202, 46080, v202
    v_lshl_add_u32 v204, v200, 4, s73
    v_add3_u32 v201, v201, v203, v204
    v_sub_u32 v8, v201, v202
    s_add_u32 m0, s5, 0
    s_nop 0
    buffer_load_dwordx4 v8, s[24:27], s70 offen lds
    v_add_u32 v200, 64, v200
    v_mul_u32_u24 v201, s74, v200
    v_mul_u32_u24 v202, s75, v200
    v_lshrrev_b32 v201, 16, v201
    v_bfe_u32 v203, v202, 18, 2
    v_lshrrev_b32 v202, 20, v202
    v_mul_u32_u24 v201, 1120, v201
    v_mul_u32_u24 v203, 15360, v203
    v_mul_u32_u24 v202, 46080, v202
    v_lshl_add_u32 v204, v200, 4, s73
    v_add3_u32 v201, v201, v203, v204
    v_sub_u32 v9, v201, v202
    s_add_u32 m0, s5, 1024
    s_nop 0
    buffer_load_dwordx4 v9, s[24:27], s70 offen lds
    v_add_u32 v200, 64, v200
    v_mul_u32_u24 v201, s74, v200
    v_mul_u32_u24 v202, s75, v200
    v_lshrrev_b32 v201, 16, v201
    v_bfe_u32 v203, v202, 18, 2
    v_lshrrev_b32 v202, 20, v202
    v_mul_u32_u24 v201, 1120, v201
    v_mul_u32_u24 v203, 15360, v203
    v_mul_u32_u24 v202, 46080, v202
    v_lshl_add_u32 v204, v200, 4, s73
    v_add3_u32 v201, v201, v203, v204
    v_sub_u32 v10, v201, v202
    s_add_u32 m0, s5, 2048
    s_nop 0
    buffer_load_dwordx4 v10, s[24:27], s70 offen lds
    v_add_u32 v200, 64, v200
    v_mul_u32_u24 v201, s74, v200
    v_mul_u32_u24 v202, s75, v200
    v_lshrrev_b32 v201, 16, v201
    v_bfe_u32 v203, v202, 18, 2
    v_lshrrev_b32 v202, 20, v202
    v_mul_u32_u24 v201, 1120, v201
    v_mul_u32_u24 v203, 15360, v203
    v_mul_u32_u24 v202, 46080, v202
    v_lshl_add_u32 v204, v200, 4, s73
    v_add3_u32 v201, v201, v203, v204
    v_sub_u32 v11, v201, v202
    s_add_u32 m0, s5, 3072
    s_mov_b64 exec, s[86:87]
    buffer_load_dwordx4 v11, s[24:27], s70 offen lds
    s_mov_b64 exec, -1
    s_add_u32 s5, s5, 15360
    s_cmp_ge_u32 s5, 76800
    s_cselect_b32 s71, 76800, 0
    s_sub_u32 s5, s5, s71
    s_add_u32 s70, s70, 122880
    s_add_u32 m0, s5, 0
    s_nop 0
    buffer_load_dwordx4 v8, s[24:27], s70 offen lds
    s_add_u32 m0, s5, 1024
    s_nop 0
    buffer_load_dwordx4 v9, s[24:27], s70 offen lds
    s_add_u32 m0, s5, 2048
    s_nop 0
    buffer_load_dwordx4 v10, s[24:27], s70 offen lds
    s_add_u32 m0, s5, 3072
    s_mov_b64 exec, s[86:87]
    buffer_load_dwordx4 v11, s[24:27], s70 offen lds
    s_mov_b64 exec, -1
    s_add_u32 s5, s5, 15360
    s_cmp_ge_u32 s5, 76800
    s_cselect_b32 s71, 76800, 0
    s_sub_u32 s5, s5, s71
    s_branch L_load2
L_B:
    s_sub_u32 s44, s19, 22
    s_and_b32 s72, s2, 7
    s_lshl_b32 s73, s72, 3
    s_add_u32 s73, s73, s44
    s_and_b32 s48, s73, 1
    s_and_b32 s45, s73, 62
    s_mul_i32 s72, s72, 10
    s_add_u32 s72, s72, s44
    s_and_b32 s53, s72, 15
    s_lshr_b32 s54, s72, 4
    v_and_b32 v1, 15, v0
    v_lshrrev_b32 v2, 4, v0
    s_and_b32 s72, s18, 3
    s_lshl_b32 s72, s72, 9
    s_lshr_b32 s73, s18, 2
    s_add_u32 s72, s72, s73
    s_add_u32 s72, s72, s45
    s_mul_i32 s73, s48, 448
    s_add_u32 s72, s72, s73
    s_mul_i32 s72, s72, 1280
    s_lshl_b32 s73, s18, 3
    s_mul_i32 s60, s48, 7
    s_add_u32 s73, s73, s60
    s_mul_i32 s73, s73, 1296
    s_lshl_b32 s60, s48, 1
    s_sub_u32 s60, 1, s60
    s_mul_i32 s61, s60, 81920
    s_mul_i32 s60, s60, 1296
    s_mov_b32 s74, -1
    s_mov_b32 s75, 0xff
    s_waitcnt lgkmcnt(0)
    s_mov_b32 s20, s10
    s_and_b32 s21, s11, 0xffff
    s_mov_b32 s22, 2621440
    s_mov_b32 s23, 0x20000
    s_cmp_ge_u32 s44, 8
    s_cbranch_scc1 L_nox_22
    s_mov_b32 m0, s73
    s_mov_b64 exec, s[74:75]
    buffer_load_dwordx4 v250, s[20:23], s72 offen lds
    buffer_load_dwordx4 v250, s[20:23], s72 offen offset:640 lds
    s_add_u32 m0, m0, s60
    s_add_u32 s72, s72, s61
    buffer_load_dwordx4 v250, s[20:23], s72 offen lds
    buffer_load_dwordx4 v250, s[20:23], s72 offen offset:640 lds
    s_add_u32 m0, m0, s60
    s_add_u32 s72, s72, s61
    buffer_load_dwordx4 v250, s[20:23], s72 offen lds
    buffer_load_dwordx4 v250, s[20:23], s72 offen offset:640 lds
    s_add_u32 m0, m0, s60
    s_add_u32 s72, s72, s61
    buffer_load_dwordx4 v250, s[20:23], s72 offen lds
    buffer_load_dwordx4 v250, s[20:23], s72 offen offset:640 lds
    s_add_u32 m0, m0, s60
    s_add_u32 s72, s72, s61
    buffer_load_dwordx4 v250, s[20:23], s72 offen lds
    buffer_load_dwordx4 v250, s[20:23], s72 offen offset:640 lds
    s_add_u32 m0, m0, s60
    s_add_u32 s72, s72, s61
    buffer_load_dwordx4 v250, s[20:23], s72 offen lds
    buffer_load_dwordx4 v250, s[20:23], s72 offen offset:640 lds
    s_add_u32 m0, m0, s60
    s_add_u32 s72, s72, s61
    buffer_load_dwordx4 v250, s[20:23], s72 offen lds
    buffer_load_dwordx4 v250, s[20:23], s72 offen offset:640 lds
    s_add_u32 m0, m0, s60
    s_add_u32 s72, s72, s61
    buffer_load_dwordx4 v250, s[20:23], s72 offen lds
    buffer_load_dwordx4 v250, s[20:23], s72 offen offset:640 lds
    s_mov_b64 exec, -1
L_nox_22:
    s_cmp_lt_u32 s44, 8
    s_cbranch_scc1 L_nopf_23
    s_getpc_b64 s[74:75]
L_pc:
    s_and_b32 s72, s44, 1
    s_lshl_b32 s72, s72, 3
    s_add_u32 s72, s72, s18
    s_lshl_b32 s72, s72, 11
    s_sub_u32 s72, s72, L_pc-concat_heads__sliding_local_dilated__spectral_fnet__prompt_kernel
    v_lshlrev_b32 v4, 7, v1
    v_add_u32 v4, s72, v4
    v_min_i32 v4, L_last-L_pc, v4
    v_ashrrev_i32 v5, 31, v4
    v_mov_b32 v6, s75
    v_add_co_u32 v4, vcc, s74, v4
    s_nop 1
    v_addc_co_u32 v5, vcc, v5, v6, vcc
    global_load_dword v255, v[4:5], off
L_nopf_23:
    s_mov_b32 s32, s16
    s_and_b32 s33, s17, 0xffff
    s_mov_b32 s34, 8388608
    s_mov_b32 s35, 0x20000
    s_mov_b32 s40, s14
    s_and_b32 s41, s15, 0xffff
    s_mov_b32 s42, 256
    s_mov_b32 s43, 0x20000
    s_mov_b32 s36, s12
    s_and_b32 s37, s13, 0xffff
    s_mov_b32 s38, 5242880
    s_mov_b32 s39, 0x20000
    v_mov_b32 v248, 0
    v_mov_b32 v254, 0
    v_bfrev_b32 v227, 1
    v_bfrev_b32 v228, 1
    v_bfrev_b32 v229, 1
    s_and_b32 s66, s19, 7
    s_and_b32 s72, s2, 7
    s_lshl_b32 s72, s72, 2
    s_lshr_b32 s73, s19, 3
    s_add_u32 s72, s72, s73
    s_add_u32 s72, s72, s66
    s_mul_i32 s73, s72, 52
    s_lshr_b32 s73, s73, 8
    s_mul_i32 s73, s73, 5
    s_sub_u32 s67, s72, s73
    s_cmp_ge_u32 s44, 8
    s_cbranch_scc1 L_b1_skip
    s_mov_b32 s24, s6
    s_and_b32 s25, s7, 0xffff
    s_mov_b32 s26, 2457600
    s_mov_b32 s27, 0x20000
    s_mov_b32 s28, s4
    s_and_b32 s29, s5, 0xffff
    s_mov_b32 s30, 2621440
    s_mov_b32 s31, 0x20000
    s_lshl_b32 s72, s44, 1
    s_and_b32 s73, s18, 1
    s_add_u32 s72, s72, s73
    s_lshr_b32 s73, s18, 1
    s_add_u32 s73, s73, 6
    s_lshl_b32 s74, s73, 4
    s_add_u32 s74, s74, s72
    s_mul_i32 s74, s74, 15360
    s_and_b32 s75, s2, 1
    s_mul_i32 s75, s75, 640
    s_add_u32 s74, s74, s75
    v_mul_u32_u24 v243, 52, v0
    v_lshrrev_b32 v243, 8, v243
    v_mul_u32_u24 v243, 640, v243
    v_lshl_add_u32 v243, v0, 7, v243
    v_add_u32 v241, s74, v243
    s_bfe_u32 s74, s2, 0x20001
    s_mul_i32 s74, s74, 22
    s_lshr_b32 s74, s74, 2
    s_mul_i32 s74, s74, 96
    s_sub_u32 s74, s74, 16
    s_mul_i32 s72, s72, 37
    s_add_u32 s74, s74, s72
    s_lshl_b32 s73, s73, 7
    s_movk_i32 s75, 2047
    v_add_u32 v244, s74, v0
    v_med3_i32 v244, v244, 0, s75
    v_mul_u32_u24 v244, 1280, v244
    v_add_u32 v242, s73, v244
    s_and_b32 s47, s18, 1
    s_lshr_b32 s46, s18, 1
    s_and_b32 s49, s18, 3
    s_lshr_b32 s58, s18, 2
    s_lshl_b32 s58, s58, 1
    s_lshl_b32 s72, s48, 15
    s_or_b32 s50, s72, 0x3f80
    s_lshl_b32 s51, s50, 16
    s_mul_i32 s72, s46, 96
    s_add_u32 s72, s72, s48
    s_mul_i32 s73, s47, 0x3e800000
    v_lshl_add_u32 v243, v1, 1, s72
    v_cvt_f32_u32 v243, v243
    v_cvt_f32_u32 v247, v2
    v_mul_f32 v247, 0x42200000, v247
    v_mul_f32 v244, 0x3e800000, v243
    v_add_f32 v244, s73, v244
    v_cos_f32 v244, v244
    v_mov_b32 v65, 0
    v_cvt_pk_bf16_f32 v64, v244, 0
    v_mul_f32 v245, 0x3acccccd, v243
    v_fma_f32 v98, v245, v247, s73
    v_add_f32 v96, v245, v245
    v_add_f32 v99, v98, v245
    v_add_f32 v100, v98, v96
    v_add_f32 v101, v99, v96
    v_cos_f32 v96, v96
    v_cos_f32 v98, v98
    v_cos_f32 v99, v99
    v_cos_f32 v100, v100
    v_cos_f32 v101, v101
    v_add_f32 v96, v96, v96
    v_add_f32 v243, 0x42000000, v243
    v_mul_f32 v245, 0x3acccccd, v243
    v_fma_f32 v106, v245, v247, s73
    v_add_f32 v104, v245, v245
    v_add_f32 v107, v106, v245
    v_add_f32 v108, v106, v104
    v_add_f32 v109, v107, v104
    v_cos_f32 v104, v104
    v_cos_f32 v106, v106
    v_cos_f32 v107, v107
    v_cos_f32 v108, v108
    v_cos_f32 v109, v109
    v_add_f32 v104, v104, v104
    v_add_f32 v243, 0x42000000, v243
    v_mul_f32 v245, 0x3acccccd, v243
    v_fma_f32 v114, v245, v247, s73
    v_add_f32 v112, v245, v245
    v_add_f32 v115, v114, v245
    v_add_f32 v116, v114, v112
    v_add_f32 v117, v115, v112
    v_cos_f32 v112, v112
    v_cos_f32 v114, v114
    v_cos_f32 v115, v115
    v_cos_f32 v116, v116
    v_cos_f32 v117, v117
    v_add_f32 v112, v112, v112
    v_cvt_pk_bf16_f32 v4, v98, v99
    v_cvt_pk_bf16_f32 v24, v106, v107
    v_cvt_pk_bf16_f32 v44, v114, v115
    v_pk_fma_f32 v[102:103], v[96:97], v[100:101], v[98:99] op_sel_hi:[0,1,1] neg_lo:[0,0,1] neg_hi:[0,0,1]
    v_cvt_pk_bf16_f32 v5, v100, v101
    v_pk_fma_f32 v[110:111], v[104:105], v[108:109], v[106:107] op_sel_hi:[0,1,1] neg_lo:[0,0,1] neg_hi:[0,0,1]
    v_cvt_pk_bf16_f32 v25, v108, v109
    v_pk_fma_f32 v[118:119], v[112:113], v[116:117], v[114:115] op_sel_hi:[0,1,1] neg_lo:[0,0,1] neg_hi:[0,0,1]
    v_cvt_pk_bf16_f32 v45, v116, v117
    v_pk_fma_f32 v[98:99], v[96:97], v[102:103], v[100:101] op_sel_hi:[0,1,1] neg_lo:[0,0,1] neg_hi:[0,0,1]
    v_cvt_pk_bf16_f32 v6, v102, v103
    v_pk_fma_f32 v[106:107], v[104:105], v[110:111], v[108:109] op_sel_hi:[0,1,1] neg_lo:[0,0,1] neg_hi:[0,0,1]
    v_cvt_pk_bf16_f32 v26, v110, v111
    v_pk_fma_f32 v[114:115], v[112:113], v[118:119], v[116:117] op_sel_hi:[0,1,1] neg_lo:[0,0,1] neg_hi:[0,0,1]
    v_cvt_pk_bf16_f32 v46, v118, v119
    v_pk_fma_f32 v[100:101], v[96:97], v[98:99], v[102:103] op_sel_hi:[0,1,1] neg_lo:[0,0,1] neg_hi:[0,0,1]
    v_cvt_pk_bf16_f32 v7, v98, v99
    v_pk_fma_f32 v[108:109], v[104:105], v[106:107], v[110:111] op_sel_hi:[0,1,1] neg_lo:[0,0,1] neg_hi:[0,0,1]
    v_cvt_pk_bf16_f32 v27, v106, v107
    v_pk_fma_f32 v[116:117], v[112:113], v[114:115], v[118:119] op_sel_hi:[0,1,1] neg_lo:[0,0,1] neg_hi:[0,0,1]
    v_cvt_pk_bf16_f32 v47, v114, v115
    v_pk_fma_f32 v[102:103], v[96:97], v[100:101], v[98:99] op_sel_hi:[0,1,1] neg_lo:[0,0,1] neg_hi:[0,0,1]
    v_cvt_pk_bf16_f32 v8, v100, v101
    v_pk_fma_f32 v[110:111], v[104:105], v[108:109], v[106:107] op_sel_hi:[0,1,1] neg_lo:[0,0,1] neg_hi:[0,0,1]
    v_cvt_pk_bf16_f32 v28, v108, v109
    v_pk_fma_f32 v[118:119], v[112:113], v[116:117], v[114:115] op_sel_hi:[0,1,1] neg_lo:[0,0,1] neg_hi:[0,0,1]
    v_cvt_pk_bf16_f32 v48, v116, v117
    v_pk_fma_f32 v[98:99], v[96:97], v[102:103], v[100:101] op_sel_hi:[0,1,1] neg_lo:[0,0,1] neg_hi:[0,0,1]
    v_cvt_pk_bf16_f32 v9, v102, v103
    v_pk_fma_f32 v[106:107], v[104:105], v[110:111], v[108:109] op_sel_hi:[0,1,1] neg_lo:[0,0,1] neg_hi:[0,0,1]
    v_cvt_pk_bf16_f32 v29, v110, v111
    v_pk_fma_f32 v[114:115], v[112:113], v[118:119], v[116:117] op_sel_hi:[0,1,1] neg_lo:[0,0,1] neg_hi:[0,0,1]
    v_cvt_pk_bf16_f32 v49, v118, v119
    v_pk_fma_f32 v[100:101], v[96:97], v[98:99], v[102:103] op_sel_hi:[0,1,1] neg_lo:[0,0,1] neg_hi:[0,0,1]
    v_cvt_pk_bf16_f32 v10, v98, v99
    v_pk_fma_f32 v[108:109], v[104:105], v[106:107], v[110:111] op_sel_hi:[0,1,1] neg_lo:[0,0,1] neg_hi:[0,0,1]
    v_cvt_pk_bf16_f32 v30, v106, v107
    v_pk_fma_f32 v[116:117], v[112:113], v[114:115], v[118:119] op_sel_hi:[0,1,1] neg_lo:[0,0,1] neg_hi:[0,0,1]
    v_cvt_pk_bf16_f32 v50, v114, v115
    v_pk_fma_f32 v[102:103], v[96:97], v[100:101], v[98:99] op_sel_hi:[0,1,1] neg_lo:[0,0,1] neg_hi:[0,0,1]
    v_cvt_pk_bf16_f32 v11, v100, v101
    v_pk_fma_f32 v[110:111], v[104:105], v[108:109], v[106:107] op_sel_hi:[0,1,1] neg_lo:[0,0,1] neg_hi:[0,0,1]
    v_cvt_pk_bf16_f32 v31, v108, v109
    v_pk_fma_f32 v[118:119], v[112:113], v[116:117], v[114:115] op_sel_hi:[0,1,1] neg_lo:[0,0,1] neg_hi:[0,0,1]
    v_cvt_pk_bf16_f32 v51, v116, v117
    v_pk_fma_f32 v[98:99], v[96:97], v[102:103], v[100:101] op_sel_hi:[0,1,1] neg_lo:[0,0,1] neg_hi:[0,0,1]
    v_cvt_pk_bf16_f32 v12, v102, v103
    v_pk_fma_f32 v[106:107], v[104:105], v[110:111], v[108:109] op_sel_hi:[0,1,1] neg_lo:[0,0,1] neg_hi:[0,0,1]
    v_cvt_pk_bf16_f32 v32, v110, v111
    v_pk_fma_f32 v[114:115], v[112:113], v[118:119], v[116:117] op_sel_hi:[0,1,1] neg_lo:[0,0,1] neg_hi:[0,0,1]
    v_cvt_pk_bf16_f32 v52, v118, v119
    v_pk_fma_f32 v[100:101], v[96:97], v[98:99], v[102:103] op_sel_hi:[0,1,1] neg_lo:[0,0,1] neg_hi:[0,0,1]
    v_cvt_pk_bf16_f32 v13, v98, v99
    v_pk_fma_f32 v[108:109], v[104:105], v[106:107], v[110:111] op_sel_hi:[0,1,1] neg_lo:[0,0,1] neg_hi:[0,0,1]
    v_cvt_pk_bf16_f32 v33, v106, v107
    v_pk_fma_f32 v[116:117], v[112:113], v[114:115], v[118:119] op_sel_hi:[0,1,1] neg_lo:[0,0,1] neg_hi:[0,0,1]
    v_cvt_pk_bf16_f32 v53, v114, v115
    v_pk_fma_f32 v[102:103], v[96:97], v[100:101], v[98:99] op_sel_hi:[0,1,1] neg_lo:[0,0,1] neg_hi:[0,0,1]
    v_cvt_pk_bf16_f32 v14, v100, v101
    v_pk_fma_f32 v[110:111], v[104:105], v[108:109], v[106:107] op_sel_hi:[0,1,1] neg_lo:[0,0,1] neg_hi:[0,0,1]
    v_cvt_pk_bf16_f32 v34, v108, v109
    v_pk_fma_f32 v[118:119], v[112:113], v[116:117], v[114:115] op_sel_hi:[0,1,1] neg_lo:[0,0,1] neg_hi:[0,0,1]
    v_cvt_pk_bf16_f32 v54, v116, v117
    v_pk_fma_f32 v[98:99], v[96:97], v[102:103], v[100:101] op_sel_hi:[0,1,1] neg_lo:[0,0,1] neg_hi:[0,0,1]
    v_cvt_pk_bf16_f32 v15, v102, v103
    v_pk_fma_f32 v[106:107], v[104:105], v[110:111], v[108:109] op_sel_hi:[0,1,1] neg_lo:[0,0,1] neg_hi:[0,0,1]
    v_cvt_pk_bf16_f32 v35, v110, v111
    v_pk_fma_f32 v[114:115], v[112:113], v[118:119], v[116:117] op_sel_hi:[0,1,1] neg_lo:[0,0,1] neg_hi:[0,0,1]
    v_cvt_pk_bf16_f32 v55, v118, v119
    v_pk_fma_f32 v[100:101], v[96:97], v[98:99], v[102:103] op_sel_hi:[0,1,1] neg_lo:[0,0,1] neg_hi:[0,0,1]
    v_cvt_pk_bf16_f32 v16, v98, v99
    v_pk_fma_f32 v[108:109], v[104:105], v[106:107], v[110:111] op_sel_hi:[0,1,1] neg_lo:[0,0,1] neg_hi:[0,0,1]
    v_cvt_pk_bf16_f32 v36, v106, v107
    v_pk_fma_f32 v[116:117], v[112:113], v[114:115], v[118:119] op_sel_hi:[0,1,1] neg_lo:[0,0,1] neg_hi:[0,0,1]
    v_cvt_pk_bf16_f32 v56, v114, v115
    v_pk_fma_f32 v[102:103], v[96:97], v[100:101], v[98:99] op_sel_hi:[0,1,1] neg_lo:[0,0,1] neg_hi:[0,0,1]
    v_cvt_pk_bf16_f32 v17, v100, v101
    v_pk_fma_f32 v[110:111], v[104:105], v[108:109], v[106:107] op_sel_hi:[0,1,1] neg_lo:[0,0,1] neg_hi:[0,0,1]
    v_cvt_pk_bf16_f32 v37, v108, v109
    v_pk_fma_f32 v[118:119], v[112:113], v[116:117], v[114:115] op_sel_hi:[0,1,1] neg_lo:[0,0,1] neg_hi:[0,0,1]
    v_cvt_pk_bf16_f32 v57, v116, v117
    v_pk_fma_f32 v[98:99], v[96:97], v[102:103], v[100:101] op_sel_hi:[0,1,1] neg_lo:[0,0,1] neg_hi:[0,0,1]
    v_cvt_pk_bf16_f32 v18, v102, v103
    v_pk_fma_f32 v[106:107], v[104:105], v[110:111], v[108:109] op_sel_hi:[0,1,1] neg_lo:[0,0,1] neg_hi:[0,0,1]
    v_cvt_pk_bf16_f32 v38, v110, v111
    v_pk_fma_f32 v[114:115], v[112:113], v[118:119], v[116:117] op_sel_hi:[0,1,1] neg_lo:[0,0,1] neg_hi:[0,0,1]
    v_cvt_pk_bf16_f32 v58, v118, v119
    v_pk_fma_f32 v[100:101], v[96:97], v[98:99], v[102:103] op_sel_hi:[0,1,1] neg_lo:[0,0,1] neg_hi:[0,0,1]
    v_cvt_pk_bf16_f32 v19, v98, v99
    v_pk_fma_f32 v[108:109], v[104:105], v[106:107], v[110:111] op_sel_hi:[0,1,1] neg_lo:[0,0,1] neg_hi:[0,0,1]
    v_cvt_pk_bf16_f32 v39, v106, v107
    v_pk_fma_f32 v[116:117], v[112:113], v[114:115], v[118:119] op_sel_hi:[0,1,1] neg_lo:[0,0,1] neg_hi:[0,0,1]
    v_cvt_pk_bf16_f32 v59, v114, v115
    v_pk_fma_f32 v[102:103], v[96:97], v[100:101], v[98:99] op_sel_hi:[0,1,1] neg_lo:[0,0,1] neg_hi:[0,0,1]
    v_cvt_pk_bf16_f32 v20, v100, v101
    v_pk_fma_f32 v[110:111], v[104:105], v[108:109], v[106:107] op_sel_hi:[0,1,1] neg_lo:[0,0,1] neg_hi:[0,0,1]
    v_cvt_pk_bf16_f32 v40, v108, v109
    v_pk_fma_f32 v[118:119], v[112:113], v[116:117], v[114:115] op_sel_hi:[0,1,1] neg_lo:[0,0,1] neg_hi:[0,0,1]
    v_cvt_pk_bf16_f32 v60, v116, v117
    v_pk_fma_f32 v[98:99], v[96:97], v[102:103], v[100:101] op_sel_hi:[0,1,1] neg_lo:[0,0,1] neg_hi:[0,0,1]
    v_cvt_pk_bf16_f32 v21, v102, v103
    v_pk_fma_f32 v[106:107], v[104:105], v[110:111], v[108:109] op_sel_hi:[0,1,1] neg_lo:[0,0,1] neg_hi:[0,0,1]
    v_cvt_pk_bf16_f32 v41, v110, v111
    v_pk_fma_f32 v[114:115], v[112:113], v[118:119], v[116:117] op_sel_hi:[0,1,1] neg_lo:[0,0,1] neg_hi:[0,0,1]
    v_cvt_pk_bf16_f32 v61, v118, v119
    v_pk_fma_f32 v[100:101], v[96:97], v[98:99], v[102:103] op_sel_hi:[0,1,1] neg_lo:[0,0,1] neg_hi:[0,0,1]
    v_cvt_pk_bf16_f32 v22, v98, v99
    v_pk_fma_f32 v[108:109], v[104:105], v[106:107], v[110:111] op_sel_hi:[0,1,1] neg_lo:[0,0,1] neg_hi:[0,0,1]
    v_cvt_pk_bf16_f32 v42, v106, v107
    v_pk_fma_f32 v[116:117], v[112:113], v[114:115], v[118:119] op_sel_hi:[0,1,1] neg_lo:[0,0,1] neg_hi:[0,0,1]
    v_cvt_pk_bf16_f32 v62, v114, v115
    v_cvt_pk_bf16_f32 v23, v100, v101
    v_cvt_pk_bf16_f32 v43, v108, v109
    v_cvt_pk_bf16_f32 v63, v116, v117
    s_cmp_eq_u32 s47, 0
    s_cselect_b32 s72, 0, 0x3e800000
    s_cselect_b32 s73, 0xbe800000, 0
    v_cvt_f32_u32 v247, v2
    v_mul_f32 v247, 4.0, v247
    v_and_b32 v244, 1, v1
    v_cmp_eq_u32 vcc, 1, v244
    v_mov_b32 v245, s72
    v_mov_b32 v246, s73
    v_cndmask_b32 v245, v245, v246, vcc
    v_bfe_i32 v132, v0, 1, 1
    v_and_b32 v132, 0x80008000, v132
    v_lshrrev_b32 v243, 1, v1
    v_add_u32 v243, 8, v243
    v_cvt_f32_u32 v243, v243
    v_mul_f32 v243, 0x3d000000, v243
    v_fma_f32 v128, v243, v247, v245
    v_add_f32 v129, v128, v243
    v_fma_f32 v130, v243, 2.0, v128
    v_fma_f32 v131, v243, 2.0, v129
    v_cos_f32 v128, v128
    v_cos_f32 v129, v129
    v_cos_f32 v130, v130
    v_cos_f32 v131, v131
    v_cvt_pk_bf16_f32 v72, v128, v129
    v_cvt_pk_bf16_f32 v73, v130, v131
    v_xor_b32 v74, v72, v132
    v_xor_b32 v75, v73, v132
    v_lshrrev_b32 v243, 1, v1
    v_lshlrev_b32 v244, 4, v244
    v_cmp_eq_u32 vcc, 0, v243
    s_nop 1
    v_cndmask_b32 v243, v243, v244, vcc
    v_cndmask_b32 v245, v245, v248, vcc
    v_cvt_f32_u32 v243, v243
    v_mul_f32 v243, 0x3d000000, v243
    v_fma_f32 v128, v243, v247, v245
    v_add_f32 v129, v128, v243
    v_fma_f32 v130, v243, 2.0, v128
    v_fma_f32 v131, v243, 2.0, v129
    v_cos_f32 v128, v128
    v_cos_f32 v129, v129
    v_cos_f32 v130, v130
    v_cos_f32 v131, v131
    v_cvt_pk_bf16_f32 v68, v128, v129
    v_cvt_pk_bf16_f32 v69, v130, v131
    v_xor_b32 v70, v68, v132
    v_xor_b32 v71, v69, v132
    s_mul_i32 s74, s47, 20736
    s_mul_i32 s75, s49, 20736
    v_mul_u32_u24 v253, 1296, v1
    v_mul_u32_u24 v247, 80, v2
    s_lshl_b32 s72, s46, 4
    s_add_u32 s73, s74, s72
    v_add3_u32 v251, v253, v247, s73
    s_add_u32 s73, s75, 64
    v_add3_u32 v224, v253, v247, s73
    v_sub_u32 v246, v253, v247
    s_sub_u32 s73, s74, s72
    s_add_u32 s73, s73, 624
    v_add_u32 v252, s73, v246
    s_add_u32 s73, s75, 560
    v_add_u32 v225, s73, v246
    s_mul_i32 s72, s47, 5
    s_add_u32 s72, s72, s46
    s_lshl_b32 s72, s72, 10
    s_add_u32 s72, s72, 82944
    v_add_u32 v254, s72, v250
    s_mul_i32 s72, s49, 5120
    s_add_u32 s72, s72, 87040
    v_add_u32 v226, s72, v250
    s_mul_i32 s72, s47, 20480
    s_add_u32 s72, s72, 82944
    v_add_u32 v230, s72, v250
    v_mul_u32_u24 v243, 784, v1
    v_lshl_add_u32 v243, v2, 3, v243
    s_mul_i32 s72, s46, 3
    s_lshl_b32 s75, s47, 6
    s_lshr_b32 s73, s72, 1
    s_lshl_b32 s73, s73, 7
    s_and_b32 s74, s72, 1
    s_lshl_b32 s74, s74, 5
    s_add_u32 s73, s73, s74
    s_add_u32 s73, s73, s75
    v_add_u32 v231, s73, v243
    s_add_u32 s72, s72, 1
    s_lshr_b32 s73, s72, 1
    s_lshl_b32 s73, s73, 7
    s_and_b32 s74, s72, 1
    s_lshl_b32 s74, s74, 5
    s_add_u32 s73, s73, s74
    s_add_u32 s73, s73, s75
    v_add_u32 v232, s73, v243
    s_add_u32 s72, s72, 1
    s_lshr_b32 s73, s72, 1
    s_lshl_b32 s73, s73, 7
    s_and_b32 s74, s72, 1
    s_lshl_b32 s74, s74, 5
    s_add_u32 s73, s73, s74
    s_add_u32 s73, s73, s75
    v_add_u32 v233, s73, v243
    s_mul_i32 s72, s18, 3136
    v_bfe_u32 v243, v0, 3, 2
    v_lshrrev_b32 v244, 5, v0
    v_and_b32 v245, 7, v0
    v_lshlrev_b32 v245, 4, v245
    v_mul_u32_u24 v246, 784, v243
    v_lshl_add_u32 v246, v244, 7, v246
    v_add3_u32 v234, v246, v245, s72
    s_mul_i32 s73, s18, 327680
    s_lshl_b32 s74, s45, 7
    s_add_u32 s73, s73, s74
    s_lshl_b32 s74, s48, 14
    s_add_u32 s73, s73, s74
    s_add_u32 s73, s73, 3145728
    s_mov_b32 s75, 163840
    v_lshrrev_b32 v246, 1, v243
    v_mad_u32_u24 v245, v246, s75, v245
    v_and_b32 v246, 1, v243
    v_lshl_add_u32 v245, v246, 13, v245
    v_lshl_add_u32 v245, v244, 15, v245
    v_add_u32 v235, s73, v245
    v_lshl_or_b32 v236, v244, 30, v235
    v_and_b32 v243, 3, v0
    v_mul_u32_u24 v244, 784, v243
    s_add_u32 s72, s72, 640
    v_add_u32 v237, s72, v244
    s_lshl_b32 s72, s18, 12
    s_lshl_b32 s73, s45, 4
    s_add_u32 s72, s72, s73
    s_add_u32 s72, s72, 6291456
    v_lshl_add_u32 v238, v243, 10, s72
    s_cmp_eq_u32 s48, 0
    s_cselect_b32 s62, 15, 0
    s_mov_b32 s63, 0
    v_or_b32 v243, s46, v2
    v_cmp_eq_u32 s[60:61], 0, v243
    s_mov_b32 s59, 0xffff0000
    v_mov_b32 v244, 0
    v_mov_b32 v245, 0
    v_mov_b32 v246, 0
    v_mov_b32 v247, 0
    s_waitcnt vmcnt(0)
    s_barrier
    ds_read_b32 v152, v252 offset:656
    ds_read_b32 v153, v252 offset:16
    ds_read_b128 v[136:139], v251 offset:0
    ds_read_b128 v[140:143], v252 offset:640
    ds_read_b128 v[144:147], v251 offset:640
    ds_read_b128 v[148:151], v252 offset:0
    ds_read_b32 v114, v253 offset:320
    ds_read_b32 v118, v253 offset:960
    ds_read_b32 v115, v253 offset:21056
    ds_read_b32 v119, v253 offset:21696
    ds_read_b32 v116, v253 offset:41792
    ds_read_b32 v120, v253 offset:42432
    ds_read_b32 v117, v253 offset:62528
    ds_read_b32 v121, v253 offset:63168
    s_mov_b32 exec_hi, 0xfffffff
    buffer_load_dword v255, v241, s[24:27], 0 offen
    s_mov_b32 exec_hi, 0x1f
    buffer_load_dword v255, v242, s[28:31], 0 offen
    s_mov_b64 exec, -1
    s_waitcnt lgkmcnt(8)
    ds_read_b32 v112, v225 offset:656
    ds_read_b32 v113, v225 offset:16
    ds_read_b128 v[96:99], v224 offset:0
    ds_read_b128 v[100:103], v225 offset:640
    ds_read_b128 v[104:107], v224 offset:640
    ds_read_b128 v[108:111], v225 offset:0
    v_cndmask_b32 v152, v152, v248, s[60:61]
    v_cndmask_b32 v153, v153, v248, s[60:61]
    v_lshlrev_b32 v156, 16, v136
    v_and_b32 v157, s59, v136
    v_lshlrev_b32 v158, 16, v137
    v_and_b32 v159, s59, v137
    v_lshlrev_b32 v160, 16, v138
    v_and_b32 v161, s59, v138
    v_lshlrev_b32 v162, 16, v139
    v_and_b32 v163, s59, v139
    v_lshlrev_b32 v164, 16, v152
    v_and_b32 v165, s59, v143
    v_lshlrev_b32 v166, 16, v143
    v_and_b32 v167, s59, v142
    v_lshlrev_b32 v168, 16, v142
    v_and_b32 v169, s59, v141
    v_lshlrev_b32 v170, 16, v141
    v_and_b32 v171, s59, v140
    v_dot2c_f32_bf16 v156, s50, v144
    v_dot2c_f32_bf16 v157, s51, v144
    v_dot2c_f32_bf16 v158, s50, v145
    v_dot2c_f32_bf16 v159, s51, v145
    v_dot2c_f32_bf16 v160, s50, v146
    v_dot2c_f32_bf16 v161, s51, v146
    v_dot2c_f32_bf16 v162, s50, v147
    v_dot2c_f32_bf16 v163, s51, v147
    v_dot2c_f32_bf16 v164, s50, v153
    v_dot2c_f32_bf16 v165, s51, v151
    v_dot2c_f32_bf16 v166, s50, v151
    v_dot2c_f32_bf16 v167, s51, v150
    v_dot2c_f32_bf16 v168, s50, v150
    v_dot2c_f32_bf16 v169, s51, v149
    v_dot2c_f32_bf16 v170, s50, v149
    v_dot2c_f32_bf16 v171, s51, v148
    v_pk_add_f32 v[176:177], v[156:157], v[164:165]
    v_pk_add_f32 v[178:179], v[158:159], v[166:167]
    v_pk_add_f32 v[180:181], v[160:161], v[168:169]
    v_pk_add_f32 v[182:183], v[162:163], v[170:171]
    v_pk_add_f32 v[184:185], v[156:157], v[164:165] neg_lo:[0,1] neg_hi:[0,1]
    v_pk_add_f32 v[186:187], v[158:159], v[166:167] neg_lo:[0,1] neg_hi:[0,1]
    v_pk_add_f32 v[188:189], v[160:161], v[168:169] neg_lo:[0,1] neg_hi:[0,1]
    v_pk_add_f32 v[190:191], v[162:163], v[170:171] neg_lo:[0,1] neg_hi:[0,1]
    v_cvt_pk_bf16_f32 v136, v176, v177
    v_cvt_pk_bf16_f32 v137, v178, v179
    v_cvt_pk_bf16_f32 v138, v180, v181
    v_cvt_pk_bf16_f32 v139, v182, v183
    ds_write_b128 v254, v[136:139] offset:0
    v_cvt_pk_bf16_f32 v144, v184, v185
    v_cvt_pk_bf16_f32 v145, v186, v187
    v_cvt_pk_bf16_f32 v146, v188, v189
    v_cvt_pk_bf16_f32 v147, v190, v191
    ds_write_b128 v254, v[144:147] offset:20480
    ds_read_b32 v152, v252 offset:42128
    ds_read_b32 v153, v252 offset:41488
    ds_read_b128 v[136:139], v251 offset:41472
    ds_read_b128 v[140:143], v252 offset:42112
    ds_read_b128 v[144:147], v251 offset:42112
    ds_read_b128 v[148:151], v252 offset:41472
    s_waitcnt lgkmcnt(8)
    v_cmp_eq_u32 vcc, 0, v2
    v_lshlrev_b32 v114, 16, v114
    v_mov_b32 v123, 0
    v_lshlrev_b32 v115, 16, v115
    v_mov_b32 v125, 0
    v_lshlrev_b32 v116, 16, v116
    v_mov_b32 v127, 0
    v_lshlrev_b32 v117, 16, v117
    v_mov_b32 v129, 0
    v_dot2c_f32_bf16 v114, s50, v118
    v_dot2c_f32_bf16 v115, s50, v119
    v_dot2c_f32_bf16 v116, s50, v120
    v_dot2c_f32_bf16 v117, s50, v121
    v_cndmask_b32 v114, v248, v114, vcc
    v_cndmask_b32 v115, v248, v115, vcc
    v_cndmask_b32 v116, v248, v116, vcc
    v_cndmask_b32 v117, v248, v117, vcc
    v_cvt_pk_bf16_f32 v122, v114, 0
    v_cvt_pk_bf16_f32 v124, v115, 0
    v_cvt_pk_bf16_f32 v126, v116, 0
    v_cvt_pk_bf16_f32 v128, v117, 0
    v_mfma_f32_16x16x16_bf16 v[76:79], v[122:123], v[64:65], 0
    v_mfma_f32_16x16x16_bf16 v[80:83], v[124:125], v[64:65], 0
    v_mfma_f32_16x16x16_bf16 v[84:87], v[126:127], v[64:65], 0
    v_mfma_f32_16x16x16_bf16 v[88:91], v[128:129], v[64:65], 0
    s_cmp_ge_u32 s18, 4
    s_cbranch_scc1 L_fsk_24
    v_lshlrev_b32 v156, 16, v96
    v_and_b32 v157, s59, v96
    v_lshlrev_b32 v158, 16, v97
    v_and_b32 v159, s59, v97
    v_lshlrev_b32 v160, 16, v98
    v_and_b32 v161, s59, v98
    v_lshlrev_b32 v162, 16, v99
    v_and_b32 v163, s59, v99
    v_lshlrev_b32 v164, 16, v112
    v_and_b32 v165, s59, v103
    v_lshlrev_b32 v166, 16, v103
    v_and_b32 v167, s59, v102
    v_lshlrev_b32 v168, 16, v102
    v_and_b32 v169, s59, v101
    v_lshlrev_b32 v170, 16, v101
    v_and_b32 v171, s59, v100
    v_dot2c_f32_bf16 v156, s50, v104
    v_dot2c_f32_bf16 v157, s51, v104
    v_dot2c_f32_bf16 v158, s50, v105
    v_dot2c_f32_bf16 v159, s51, v105
    v_dot2c_f32_bf16 v160, s50, v106
    v_dot2c_f32_bf16 v161, s51, v106
    v_dot2c_f32_bf16 v162, s50, v107
    v_dot2c_f32_bf16 v163, s51, v107
    v_dot2c_f32_bf16 v164, s50, v113
    v_dot2c_f32_bf16 v165, s51, v111
    v_dot2c_f32_bf16 v166, s50, v111
    v_dot2c_f32_bf16 v167, s51, v110
    v_dot2c_f32_bf16 v168, s50, v110
    v_dot2c_f32_bf16 v169, s51, v109
    v_dot2c_f32_bf16 v170, s50, v109
    v_dot2c_f32_bf16 v171, s51, v108
    v_pk_add_f32 v[176:177], v[156:157], v[164:165]
    v_pk_add_f32 v[178:179], v[158:159], v[166:167]
    v_pk_add_f32 v[180:181], v[160:161], v[168:169]
    v_pk_add_f32 v[182:183], v[162:163], v[170:171]
    v_pk_add_f32 v[184:185], v[156:157], v[164:165] neg_lo:[0,1] neg_hi:[0,1]
    v_pk_add_f32 v[186:187], v[158:159], v[166:167] neg_lo:[0,1] neg_hi:[0,1]
    v_pk_add_f32 v[188:189], v[160:161], v[168:169] neg_lo:[0,1] neg_hi:[0,1]
    v_pk_add_f32 v[190:191], v[162:163], v[170:171] neg_lo:[0,1] neg_hi:[0,1]
    v_cvt_pk_bf16_f32 v96, v176, v177
    v_cvt_pk_bf16_f32 v97, v178, v179
    v_cvt_pk_bf16_f32 v98, v180, v181
    v_cvt_pk_bf16_f32 v99, v182, v183
    ds_write_b128 v226, v[96:99] offset:0
    v_cvt_pk_bf16_f32 v104, v184, v185
    v_cvt_pk_bf16_f32 v105, v186, v187
    v_cvt_pk_bf16_f32 v106, v188, v189
    v_cvt_pk_bf16_f32 v107, v190, v191
    ds_write_b128 v226, v[104:107] offset:20480
L_fsk_24:
    s_waitcnt lgkmcnt(0)
    s_barrier
    ds_read_b128 v[96:99], v230 offset:0
    ds_read_b128 v[116:119], v230 offset:5120
    ds_read_b128 v[100:103], v230 offset:1024
    ds_read_b128 v[120:123], v230 offset:6144
    ds_read_b128 v[104:107], v230 offset:2048
    ds_read_b128 v[124:127], v230 offset:7168
    ds_read_b128 v[108:111], v230 offset:3072
    ds_read_b128 v[128:131], v230 offset:8192
    ds_read_b128 v[112:115], v230 offset:4096
    ds_read_b128 v[132:135], v230 offset:9216
    v_cndmask_b32 v152, v152, v248, s[60:61]
    v_cndmask_b32 v153, v153, v248, s[60:61]
    v_lshlrev_b32 v156, 16, v136
    v_and_b32 v157, s59, v136
    v_lshlrev_b32 v158, 16, v137
    v_and_b32 v159, s59, v137
    v_lshlrev_b32 v160, 16, v138
    v_and_b32 v161, s59, v138
    v_lshlrev_b32 v162, 16, v139
    v_and_b32 v163, s59, v139
    v_lshlrev_b32 v164, 16, v152
    v_and_b32 v165, s59, v143
    v_lshlrev_b32 v166, 16, v143
    v_and_b32 v167, s59, v142
    v_lshlrev_b32 v168, 16, v142
    v_and_b32 v169, s59, v141
    v_lshlrev_b32 v170, 16, v141
    v_and_b32 v171, s59, v140
    v_dot2c_f32_bf16 v156, s50, v144
    v_dot2c_f32_bf16 v157, s51, v144
    v_dot2c_f32_bf16 v158, s50, v145
    v_dot2c_f32_bf16 v159, s51, v145
    v_dot2c_f32_bf16 v160, s50, v146
    v_dot2c_f32_bf16 v161, s51, v146
    v_dot2c_f32_bf16 v162, s50, v147
    v_dot2c_f32_bf16 v163, s51, v147
    v_dot2c_f32_bf16 v164, s50, v153
    v_dot2c_f32_bf16 v165, s51, v151
    v_dot2c_f32_bf16 v166, s50, v151
    v_dot2c_f32_bf16 v167, s51, v150
    v_dot2c_f32_bf16 v168, s50, v150
    v_dot2c_f32_bf16 v169, s51, v149
    v_dot2c_f32_bf16 v170, s50, v149
    v_dot2c_f32_bf16 v171, s51, v148
    v_pk_add_f32 v[176:177], v[156:157], v[164:165]
    v_pk_add_f32 v[178:179], v[158:159], v[166:167]
    v_pk_add_f32 v[180:181], v[160:161], v[168:169]
    v_pk_add_f32 v[182:183], v[162:163], v[170:171]
    v_pk_add_f32 v[184:185], v[156:157], v[164:165] neg_lo:[0,1] neg_hi:[0,1]
    v_pk_add_f32 v[186:187], v[158:159], v[166:167] neg_lo:[0,1] neg_hi:[0,1]
    v_pk_add_f32 v[188:189], v[160:161], v[168:169] neg_lo:[0,1] neg_hi:[0,1]
    v_pk_add_f32 v[190:191], v[162:163], v[170:171] neg_lo:[0,1] neg_hi:[0,1]
    v_cvt_pk_bf16_f32 v136, v176, v177
    v_cvt_pk_bf16_f32 v137, v178, v179
    v_cvt_pk_bf16_f32 v138, v180, v181
    v_cvt_pk_bf16_f32 v139, v182, v183
    ds_write_b128 v254, v[136:139] offset:10240
    v_cvt_pk_bf16_f32 v144, v184, v185
    v_cvt_pk_bf16_f32 v145, v186, v187
    v_cvt_pk_bf16_f32 v146, v188, v189
    v_cvt_pk_bf16_f32 v147, v190, v191
    ds_write_b128 v254, v[144:147] offset:30720
    s_waitcnt lgkmcnt(10)
    v_mfma_f32_16x16x32_bf16 v[200:203], v[96:99], v[4:7], v[76:79]
    v_mfma_f32_16x16x32_bf16 v[204:207], v[116:119], v[4:7], v[80:83]
    v_mfma_f32_16x16x32_bf16 v[208:211], v[96:99], v[24:27], v[76:79]
    v_mfma_f32_16x16x32_bf16 v[212:215], v[116:119], v[24:27], v[80:83]
    v_mfma_f32_16x16x32_bf16 v[216:219], v[96:99], v[44:47], v[76:79]
    v_mfma_f32_16x16x32_bf16 v[220:223], v[116:119], v[44:47], v[80:83]
    s_waitcnt lgkmcnt(8)
    v_mfma_f32_16x16x32_bf16 v[200:203], v[100:103], v[8:11], v[200:203]
    v_mfma_f32_16x16x32_bf16 v[204:207], v[120:123], v[8:11], v[204:207]
    v_mfma_f32_16x16x32_bf16 v[208:211], v[100:103], v[28:31], v[208:211]
    v_mfma_f32_16x16x32_bf16 v[212:215], v[120:123], v[28:31], v[212:215]
    v_mfma_f32_16x16x32_bf16 v[216:219], v[100:103], v[48:51], v[216:219]
    v_mfma_f32_16x16x32_bf16 v[220:223], v[120:123], v[48:51], v[220:223]
    s_waitcnt lgkmcnt(6)
    v_mfma_f32_16x16x32_bf16 v[200:203], v[104:107], v[12:15], v[200:203]
    v_mfma_f32_16x16x32_bf16 v[204:207], v[124:127], v[12:15], v[204:207]
    v_mfma_f32_16x16x32_bf16 v[208:211], v[104:107], v[32:35], v[208:211]
    v_mfma_f32_16x16x32_bf16 v[212:215], v[124:127], v[32:35], v[212:215]
    v_mfma_f32_16x16x32_bf16 v[216:219], v[104:107], v[52:55], v[216:219]
    v_mfma_f32_16x16x32_bf16 v[220:223], v[124:127], v[52:55], v[220:223]
    s_waitcnt lgkmcnt(4)
    v_mfma_f32_16x16x32_bf16 v[200:203], v[108:111], v[16:19], v[200:203]
    v_mfma_f32_16x16x32_bf16 v[204:207], v[128:131], v[16:19], v[204:207]
    v_mfma_f32_16x16x32_bf16 v[208:211], v[108:111], v[36:39], v[208:211]
    v_mfma_f32_16x16x32_bf16 v[212:215], v[128:131], v[36:39], v[212:215]
    v_mfma_f32_16x16x32_bf16 v[216:219], v[108:111], v[56:59], v[216:219]
    v_mfma_f32_16x16x32_bf16 v[220:223], v[128:131], v[56:59], v[220:223]
    s_waitcnt lgkmcnt(2)
    v_mfma_f32_16x16x32_bf16 v[200:203], v[112:115], v[20:23], v[200:203]
    v_mfma_f32_16x16x32_bf16 v[204:207], v[132:135], v[20:23], v[204:207]
    v_mfma_f32_16x16x32_bf16 v[208:211], v[112:115], v[40:43], v[208:211]
    v_mfma_f32_16x16x32_bf16 v[212:215], v[132:135], v[40:43], v[212:215]
    v_mfma_f32_16x16x32_bf16 v[216:219], v[112:115], v[60:63], v[216:219]
    v_mfma_f32_16x16x32_bf16 v[220:223], v[132:135], v[60:63], v[220:223]
    s_waitcnt lgkmcnt(0)
    s_barrier
    ds_read_b128 v[136:139], v230 offset:10240
    ds_read_b128 v[156:159], v230 offset:15360
    ds_read_b128 v[140:143], v230 offset:11264
    ds_read_b128 v[160:163], v230 offset:16384
    ds_read_b128 v[144:147], v230 offset:12288
    ds_read_b128 v[164:167], v230 offset:17408
    ds_read_b128 v[148:151], v230 offset:13312
    ds_read_b128 v[168:171], v230 offset:18432
    ds_read_b128 v[152:155], v230 offset:14336
    ds_read_b128 v[172:175], v230 offset:19456
    v_cvt_pk_bf16_f32 v96, v200, v201
    v_cvt_pk_bf16_f32 v97, v202, v203
    v_cvt_pk_bf16_f32 v98, v204, v205
    v_cvt_pk_bf16_f32 v99, v206, v207
    v_cvt_pk_bf16_f32 v100, v208, v209
    v_cvt_pk_bf16_f32 v101, v210, v211
    v_cvt_pk_bf16_f32 v102, v212, v213
    v_cvt_pk_bf16_f32 v103, v214, v215
    v_cvt_pk_bf16_f32 v104, v216, v217
    v_cvt_pk_bf16_f32 v105, v218, v219
    v_cvt_pk_bf16_f32 v106, v220, v221
    v_cvt_pk_bf16_f32 v107, v222, v223
    v_mfma_f32_16x16x32_bf16 v[108:111], v[96:99], v[68:71], 0
    v_mfma_f32_16x16x32_bf16 v[112:115], v[96:99], v[72:75], 0
    v_mfma_f32_16x16x32_bf16 v[116:119], v[100:103], v[68:71], 0
    v_mfma_f32_16x16x32_bf16 v[120:123], v[100:103], v[72:75], 0
    v_mfma_f32_16x16x32_bf16 v[124:127], v[104:107], v[68:71], 0
    v_mfma_f32_16x16x32_bf16 v[128:131], v[104:107], v[72:75], 0
    s_waitcnt lgkmcnt(8)
    v_mfma_f32_16x16x32_bf16 v[200:203], v[136:139], v[4:7], v[84:87]
    v_mfma_f32_16x16x32_bf16 v[204:207], v[156:159], v[4:7], v[88:91]
    v_mfma_f32_16x16x32_bf16 v[208:211], v[136:139], v[24:27], v[84:87]
    v_mfma_f32_16x16x32_bf16 v[212:215], v[156:159], v[24:27], v[88:91]
    v_mfma_f32_16x16x32_bf16 v[216:219], v[136:139], v[44:47], v[84:87]
    v_cvt_pk_bf16_f32 v176, v108, v109
    v_cvt_pk_bf16_f32 v177, v110, v111
    ds_write_b64 v231, v[176:177] offset:0
    v_mfma_f32_16x16x32_bf16 v[220:223], v[156:159], v[44:47], v[88:91]
    s_waitcnt lgkmcnt(7)
    v_mfma_f32_16x16x32_bf16 v[200:203], v[140:143], v[8:11], v[200:203]
    v_mfma_f32_16x16x32_bf16 v[204:207], v[160:163], v[8:11], v[204:207]
    v_mfma_f32_16x16x32_bf16 v[208:211], v[140:143], v[28:31], v[208:211]
    v_cvt_pk_bf16_f32 v178, v112, v113
    v_cvt_pk_bf16_f32 v179, v114, v115
    ds_write_b64 v231, v[178:179] offset:12544
    v_mfma_f32_16x16x32_bf16 v[212:215], v[160:163], v[28:31], v[212:215]
    v_mfma_f32_16x16x32_bf16 v[216:219], v[140:143], v[48:51], v[216:219]
    v_mfma_f32_16x16x32_bf16 v[220:223], v[160:163], v[48:51], v[220:223]
    s_waitcnt lgkmcnt(6)
    v_mfma_f32_16x16x32_bf16 v[200:203], v[144:147], v[12:15], v[200:203]
    v_cvt_pk_bf16_f32 v180, v116, v117
    v_cvt_pk_bf16_f32 v181, v118, v119
    ds_write_b64 v232, v[180:181] offset:0
    v_mfma_f32_16x16x32_bf16 v[204:207], v[164:167], v[12:15], v[204:207]
    v_mfma_f32_16x16x32_bf16 v[208:211], v[144:147], v[32:35], v[208:211]
    v_mfma_f32_16x16x32_bf16 v[212:215], v[164:167], v[32:35], v[212:215]
    v_mfma_f32_16x16x32_bf16 v[216:219], v[144:147], v[52:55], v[216:219]
    v_cvt_pk_bf16_f32 v182, v120, v121
    v_cvt_pk_bf16_f32 v183, v122, v123
    ds_write_b64 v232, v[182:183] offset:12544
    v_mfma_f32_16x16x32_bf16 v[220:223], v[164:167], v[52:55], v[220:223]
    s_waitcnt lgkmcnt(6)
    v_mfma_f32_16x16x32_bf16 v[200:203], v[148:151], v[16:19], v[200:203]
    v_mfma_f32_16x16x32_bf16 v[204:207], v[168:171], v[16:19], v[204:207]
    v_mfma_f32_16x16x32_bf16 v[208:211], v[148:151], v[36:39], v[208:211]
    v_cvt_pk_bf16_f32 v184, v124, v125
    v_cvt_pk_bf16_f32 v185, v126, v127
    ds_write_b64 v233, v[184:185] offset:0
    v_mfma_f32_16x16x32_bf16 v[212:215], v[168:171], v[36:39], v[212:215]
    v_mfma_f32_16x16x32_bf16 v[216:219], v[148:151], v[56:59], v[216:219]
    v_mfma_f32_16x16x32_bf16 v[220:223], v[168:171], v[56:59], v[220:223]
    s_waitcnt lgkmcnt(5)
    v_mfma_f32_16x16x32_bf16 v[200:203], v[152:155], v[20:23], v[200:203]
    v_cvt_pk_bf16_f32 v186, v128, v129
    v_cvt_pk_bf16_f32 v187, v130, v131
    ds_write_b64 v233, v[186:187] offset:12544
    v_mfma_f32_16x16x32_bf16 v[204:207], v[172:175], v[20:23], v[204:207]
    v_mfma_f32_16x16x32_bf16 v[208:211], v[152:155], v[40:43], v[208:211]
    v_mfma_f32_16x16x32_bf16 v[212:215], v[172:175], v[40:43], v[212:215]
    v_mfma_f32_16x16x32_bf16 v[216:219], v[152:155], v[60:63], v[216:219]
    v_mfma_f32_16x16x32_bf16 v[220:223], v[172:175], v[60:63], v[220:223]
    s_waitcnt lgkmcnt(0)
    s_barrier
    v_mov_b32 v243, 118784
    ds_write_b128 v243, v[244:247]
    ds_read_b128 v[4:7], v234 offset:0
    ds_read_b128 v[8:11], v234 offset:256
    ds_read_b128 v[12:15], v234 offset:512
    ds_read_b128 v[16:19], v237 offset:0
    v_cvt_pk_bf16_f32 v136, v200, v201
    v_cvt_pk_bf16_f32 v137, v202, v203
    v_cvt_pk_bf16_f32 v138, v204, v205
    v_cvt_pk_bf16_f32 v139, v206, v207
    v_cvt_pk_bf16_f32 v140, v208, v209
    v_cvt_pk_bf16_f32 v141, v210, v211
    v_cvt_pk_bf16_f32 v142, v212, v213
    v_cvt_pk_bf16_f32 v143, v214, v215
    v_cvt_pk_bf16_f32 v144, v216, v217
    v_cvt_pk_bf16_f32 v145, v218, v219
    v_cvt_pk_bf16_f32 v146, v220, v221
    v_cvt_pk_bf16_f32 v147, v222, v223
    v_mfma_f32_16x16x32_bf16 v[148:151], v[136:139], v[68:71], 0
    v_mfma_f32_16x16x32_bf16 v[152:155], v[136:139], v[72:75], 0
    v_mfma_f32_16x16x32_bf16 v[156:159], v[140:143], v[68:71], 0
    v_mfma_f32_16x16x32_bf16 v[160:163], v[140:143], v[72:75], 0
    v_mfma_f32_16x16x32_bf16 v[164:167], v[144:147], v[68:71], 0
    v_mfma_f32_16x16x32_bf16 v[168:171], v[144:147], v[72:75], 0
    s_mov_b32 s72, 0
    s_waitcnt lgkmcnt(3)
    buffer_store_dwordx4 v[4:7], v235, s[32:35], s72 offen offset:0 sc1
    s_mov_b32 s72, 65536
    s_waitcnt lgkmcnt(2)
    buffer_store_dwordx4 v[8:11], v235, s[32:35], s72 offen offset:0 sc1
    s_mov_b32 s72, 131072
    s_waitcnt lgkmcnt(1)
    buffer_store_dwordx4 v[12:15], v236, s[32:35], s72 offen offset:0 sc1
    s_waitcnt lgkmcnt(0)
    s_mov_b64 exec, s[62:63]
    s_cbranch_execz L_nox320_25
    buffer_store_dwordx4 v[16:19], v238, s[32:35], 0 offen offset:0 sc1
L_nox320_25:
    s_mov_b64 exec, -1
    v_cvt_pk_bf16_f32 v188, v148, v149
    v_cvt_pk_bf16_f32 v189, v150, v151
    ds_write_b64 v231, v[188:189] offset:25088
    v_cvt_pk_bf16_f32 v190, v152, v153
    v_cvt_pk_bf16_f32 v191, v154, v155
    ds_write_b64 v231, v[190:191] offset:37632
    v_cvt_pk_bf16_f32 v192, v156, v157
    v_cvt_pk_bf16_f32 v193, v158, v159
    ds_write_b64 v232, v[192:193] offset:25088
    v_cvt_pk_bf16_f32 v194, v160, v161
    v_cvt_pk_bf16_f32 v195, v162, v163
    ds_write_b64 v232, v[194:195] offset:37632
    v_cvt_pk_bf16_f32 v196, v164, v165
    v_cvt_pk_bf16_f32 v197, v166, v167
    ds_write_b64 v233, v[196:197] offset:25088
    v_cvt_pk_bf16_f32 v198, v168, v169
    v_cvt_pk_bf16_f32 v199, v170, v171
    ds_write_b64 v233, v[198:199] offset:37632
    s_waitcnt lgkmcnt(0)
    s_barrier
    ds_read_b128 v[20:23], v234 offset:25088
    ds_read_b128 v[24:27], v234 offset:25344
    ds_read_b128 v[28:31], v234 offset:25600
    ds_read_b128 v[32:35], v237 offset:25088
    s_mov_b32 s72, 0
    s_waitcnt lgkmcnt(3)
    buffer_store_dwordx4 v[20:23], v235, s[32:35], s72 offen offset:128 sc1
    s_mov_b32 s72, 65536
    s_waitcnt lgkmcnt(2)
    buffer_store_dwordx4 v[24:27], v235, s[32:35], s72 offen offset:128 sc1
    s_mov_b32 s72, 131072
    s_waitcnt lgkmcnt(1)
    buffer_store_dwordx4 v[28:31], v236, s[32:35], s72 offen offset:128 sc1
    s_waitcnt lgkmcnt(0)
    s_mov_b64 exec, s[62:63]
    s_cbranch_execz L_nox320_26
    buffer_store_dwordx4 v[32:35], v238, s[32:35], 0 offen offset:16 sc1
L_nox320_26:
    s_mov_b64 exec, -1
    s_and_b32 s73, s2, 7
    s_lshl_b32 s72, s73, 7
    s_add_u32 s72, s72, 6838272
    s_lshl_b32 s73, s73, 2
    s_add_u32 s73, s73, 128
    buffer_load_dword v249, v248, s[40:43], 0 offen sc1
    s_waitcnt vmcnt(0) lgkmcnt(0)
    s_barrier
    s_cmp_lg_u32 s18, 4
    s_cbranch_scc1 L_split
    s_mov_b32 s77, 0
L_rdy_28:
    v_readfirstlane_b32 s76, v249
    s_nop 2
    s_cmp_lg_u32 s76, 0
    s_cbranch_scc1 L_rdy_ok_29
    s_add_u32 s77, s77, 1
    s_cmp_gt_u32 s77, 20000
    s_cbranch_scc1 L_rdy_ok_29
    s_sleep 2
    buffer_load_dword v249, v248, s[40:43], 0 offen sc1
    s_waitcnt vmcnt(0)
    s_branch L_rdy_28
L_rdy_ok_29:
    v_mov_b32 v249, 1
    s_or_b32 s72, s45, s48
    s_lshl_b32 s72, s72, 7
    s_add_u32 s72, s72, 6840320
    s_mov_b64 exec, 1
    buffer_store_dword v249, v248, s[32:35], s72 offen sc1
L_noarr_27:
    s_mov_b64 exec, -1
    s_branch L_split
L_b1_skip:
    s_and_b32 s72, s2, 7
    s_lshl_b32 s72, s72, 1
    s_and_b32 s73, s44, 1
    s_add_u32 s72, s72, s73
    s_mul_i32 s72, s72, 2048
    s_add_u32 s72, s72, 6815744
    v_mov_b32 v12, 0
    v_mov_b32 v13, 0
    v_mov_b32 v14, 0
    v_mov_b32 v15, 0
    v_mov_b32 v243, 118784
    ds_write_b128 v243, v[12:15]
    v_lshlrev_b32 v244, 7, v0
    s_mov_b32 s20, s4
    s_and_b32 s21, s5, 0xffff
    s_mov_b32 s22, 2621440
    s_mov_b32 s23, 0x20000
    s_mov_b32 s24, s6
    s_and_b32 s25, s7, 0xffff
    s_mov_b32 s26, 2457600
    s_mov_b32 s27, 0x20000
    s_and_b32 s73, s44, 1
    s_lshl_b32 s73, s73, 3
    s_add_u32 s73, s73, s18
    s_bfe_u32 s74, s2, 0x20001
    s_and_b32 s59, s74, 1
    s_mul_i32 s74, s74, 22
    s_lshr_b32 s74, s74, 2
    s_lshr_b32 s60, s73, 1
    s_add_u32 s60, s60, s59
    s_and_b32 s61, s73, 1
    s_mul_i32 s61, s61, 3
    s_add_u32 s61, s61, 2
    s_cmp_eq_u32 s59, 0
    s_cselect_b32 s62, 5, 0
    s_mov_b32 s63, 0x002105
    s_cselect_b32 s63, 0x445432, s63
    s_sub_u32 s75, s73, 10
    s_lshl_b32 s75, s75, 2
    s_lshr_b32 s63, s63, s75
    s_and_b32 s63, s63, 15
    s_cmp_lt_u32 s73, 10
    s_cselect_b32 s60, s60, s62
    s_cselect_b32 s61, s61, s63
    s_add_u32 s60, s60, s74
    s_add_u32 s61, s61, s60
    s_mul_i32 s74, s61, 342
    s_lshr_b32 s74, s74, 11
    s_mul_i32 s74, s74, 6
    s_sub_u32 s61, s61, s74
    s_cmp_ge_u32 s73, 14
    s_cbranch_scc1 L_pfw_31
    s_lshl_b32 s73, s61, 7
    s_mul_i32 s60, s60, 96
    s_sub_u32 s60, s60, 16
    s_movk_i32 s61, 2047
    v_add_u32 v245, s60, v0
    v_med3_i32 v245, v245, 0, s61
    v_mul_u32_u24 v245, 1280, v245
    buffer_load_dword v255, v245, s[20:23], s73 offen
    v_add_u32 v245, s60, v0
    v_add_u32 v245, 48, v245
    v_med3_i32 v245, v245, 0, s61
    v_mul_u32_u24 v245, 1280, v245
    buffer_load_dword v255, v245, s[20:23], s73 offen
    s_branch L_pfd_32
L_pfw_31:
    s_lshl_b32 s61, s61, 1
    s_and_b32 s73, s73, 1
    s_add_u32 s61, s61, s73
    s_mul_i32 s61, s61, 122880
    s_xor_b32 s59, s59, 1
    s_lshl_b32 s59, s59, 9
    s_and_b32 s73, s2, 1
    s_mul_i32 s73, s73, 640
    s_add_u32 s61, s61, s59
    s_add_u32 s61, s61, s73
    v_mul_u32_u24 v245, 1280, v0
    buffer_load_dword v255, v245, s[24:27], s61 offen
    v_add_u32 v245, 81920, v245
    s_mov_b32 exec_hi, 0
    buffer_load_dword v255, v245, s[24:27], s61 offen
    s_mov_b64 exec, -1
L_pfd_32:
    s_cmp_lt_u32 s44, 8
    s_cbranch_scc1 L_nopre_30
    s_cmp_lg_u32 s18, 4
    s_cbranch_scc1 L_nopre_30
    s_mov_b64 exec, 0xffff
    buffer_store_dword v12, v244, s[32:35], s72 offen sc1
    s_waitcnt vmcnt(0)
    s_mov_b64 exec, 1
    v_mov_b32 v243, 1
    v_mov_b32 v244, 1
    buffer_atomic_add v243, v248, s[40:43], 0 offen offset:192 sc0 sc1
    s_waitcnt vmcnt(0)
    v_cmp_eq_u32 vcc, 15, v243
    s_nop 2
    s_and_b64 exec, exec, vcc
    s_cbranch_execz L_nopre_30
    buffer_store_dword v244, v248, s[40:43], 0 offen offset:0 sc1
L_nopre_30:
    s_mov_b64 exec, -1
    s_waitcnt lgkmcnt(0)
    s_barrier
L_split:
    s_cmp_ge_u32 s18, 4
    s_cbranch_scc1 L_b2w_33
    buffer_load_dword v249, v248, s[40:43], 0 offen sc1
    s_mov_b32 s28, s8
    s_and_b32 s29, s9, 0xffff
    s_mov_b32 s30, 819200
    s_mov_b32 s31, 0x20000
    s_and_b32 s73, s18, 3
    s_lshl_b32 s72, s67, 2
    s_add_u32 s72, s72, s73
    s_mul_i32 s68, s72, 40960
    s_mul_i32 s69, s73, 5120
    s_movk_i32 s73, 6554
    s_mul_i32 s74, s66, 160
    s_movk_i32 s75, 1280
    v_add_u32 v243, 0, v0
    v_mul_u32_u24 v244, s73, v243
    v_lshrrev_b32 v244, 16, v244
    v_mul_u32_u24 v245, 10, v244
    v_sub_u32 v246, v243, v245
    v_lshl_add_u32 v246, v246, 4, s74
    v_bfe_u32 v245, v244, 2, 2
    v_lshl_add_u32 v245, v245, 2, v244
    v_lshrrev_b32 v247, 4, v244
    v_mul_u32_u24 v247, 12, v247
    v_sub_u32 v245, v245, v247
    v_mad_u32_u24 v238, v245, s75, v246
    v_add_u32 v243, 64, v0
    v_mul_u32_u24 v244, s73, v243
    v_lshrrev_b32 v244, 16, v244
    v_mul_u32_u24 v245, 10, v244
    v_sub_u32 v246, v243, v245
    v_lshl_add_u32 v246, v246, 4, s74
    v_bfe_u32 v245, v244, 2, 2
    v_lshl_add_u32 v245, v245, 2, v244
    v_lshrrev_b32 v247, 4, v244
    v_mul_u32_u24 v247, 12, v247
    v_sub_u32 v245, v245, v247
    v_mad_u32_u24 v239, v245, s75, v246
    v_add_u32 v243, 128, v0
    v_mul_u32_u24 v244, s73, v243
    v_lshrrev_b32 v244, 16, v244
    v_mul_u32_u24 v245, 10, v244
    v_sub_u32 v246, v243, v245
    v_lshl_add_u32 v246, v246, 4, s74
    v_bfe_u32 v245, v244, 2, 2
    v_lshl_add_u32 v245, v245, 2, v244
    v_lshrrev_b32 v247, 4, v244
    v_mul_u32_u24 v247, 12, v247
    v_sub_u32 v245, v245, v247
    v_mad_u32_u24 v240, v245, s75, v246
    v_add_u32 v243, 192, v0
    v_mul_u32_u24 v244, s73, v243
    v_lshrrev_b32 v244, 16, v244
    v_mul_u32_u24 v245, 10, v244
    v_sub_u32 v246, v243, v245
    v_lshl_add_u32 v246, v246, 4, s74
    v_bfe_u32 v245, v244, 2, 2
    v_lshl_add_u32 v245, v245, 2, v244
    v_lshrrev_b32 v247, 4, v244
    v_mul_u32_u24 v247, 12, v247
    v_sub_u32 v245, v245, v247
    v_mad_u32_u24 v241, v245, s75, v246
    v_add_u32 v243, 256, v0
    v_mul_u32_u24 v244, s73, v243
    v_lshrrev_b32 v244, 16, v244
    v_mul_u32_u24 v245, 10, v244
    v_sub_u32 v246, v243, v245
    v_lshl_add_u32 v246, v246, 4, s74
    v_bfe_u32 v245, v244, 2, 2
    v_lshl_add_u32 v245, v245, 2, v244
    v_lshrrev_b32 v247, 4, v244
    v_mul_u32_u24 v247, 12, v247
    v_sub_u32 v245, v245, v247
    v_mad_u32_u24 v242, v245, s75, v246
    s_and_b32 s72, s2, 7
    s_lshl_b32 s72, s72, 2
    s_lshr_b32 s73, s19, 3
    s_add_u32 s72, s72, s73
    s_lshl_b32 s74, s72, 2
    s_add_u32 s74, s74, s18
    s_mul_i32 s73, s74, 43
    s_lshr_b32 s73, s73, 8
    s_lshl_b32 s73, s73, 10
    s_add_u32 s83, s73, 6815744
    s_mul_i32 s73, s74, 20480
    s_add_u32 s75, s67, 0
    s_cmp_ge_u32 s75, 5
    s_cselect_b32 s71, 5, 0
    s_sub_u32 s75, s75, s71
    s_lshl_b32 s75, s75, 12
    s_add_u32 s78, s75, s73
    s_add_u32 s75, s67, 1
    s_cmp_ge_u32 s75, 5
    s_cselect_b32 s71, 5, 0
    s_sub_u32 s75, s75, s71
    s_lshl_b32 s75, s75, 12
    s_add_u32 s79, s75, s73
    s_add_u32 s75, s67, 2
    s_cmp_ge_u32 s75, 5
    s_cselect_b32 s71, 5, 0
    s_sub_u32 s75, s75, s71
    s_lshl_b32 s75, s75, 12
    s_add_u32 s80, s75, s73
    s_add_u32 s75, s67, 3
    s_cmp_ge_u32 s75, 5
    s_cselect_b32 s71, 5, 0
    s_sub_u32 s75, s75, s71
    s_lshl_b32 s75, s75, 12
    s_add_u32 s81, s75, s73
    s_add_u32 s75, s67, 4
    s_cmp_ge_u32 s75, 5
    s_cselect_b32 s71, 5, 0
    s_sub_u32 s75, s75, s71
    s_lshl_b32 s75, s75, 12
    s_add_u32 s82, s75, s73
    s_lshr_b32 s72, s74, 1
    s_lshl_b32 s72, s72, 5
    s_and_b32 s73, s74, 1
    s_add_u32 s72, s72, s73
    s_mul_i32 s72, s72, 2560
    s_mul_i32 s73, s66, 160
    s_add_u32 s72, s72, s73
    s_mul_i32 s73, s18, 2816
    s_add_u32 s73, s73, 107520
    s_movk_i32 s75, 6554
    v_add_u32 v243, 0, v0
    v_mul_u32_u24 v244, s75, v243
    v_lshrrev_b32 v244, 16, v244
    v_mul_u32_u24 v245, 10, v244
    v_sub_u32 v243, v243, v245
    v_lshlrev_b32 v243, 4, v243
    v_mul_u32_u24 v245, 176, v244
    v_add3_u32 v224, v245, v243, s73
    v_mul_u32_u24 v245, 5120, v244
    v_add3_u32 v227, v245, v243, s72
    v_add_u32 v243, 64, v0
    v_mul_u32_u24 v244, s75, v243
    v_lshrrev_b32 v244, 16, v244
    v_mul_u32_u24 v245, 10, v244
    v_sub_u32 v243, v243, v245
    v_lshlrev_b32 v243, 4, v243
    v_mul_u32_u24 v245, 176, v244
    v_add3_u32 v225, v245, v243, s73
    v_mul_u32_u24 v245, 5120, v244
    v_add3_u32 v228, v245, v243, s72
    v_add_u32 v243, 128, v0
    v_mul_u32_u24 v244, s75, v243
    v_lshrrev_b32 v244, 16, v244
    v_mul_u32_u24 v245, 10, v244
    v_sub_u32 v243, v243, v245
    v_lshlrev_b32 v243, 4, v243
    v_mul_u32_u24 v245, 176, v244
    v_add3_u32 v226, v245, v243, s73
    v_mul_u32_u24 v245, 5120, v244
    v_add3_u32 v229, v245, v243, s72
    v_lshrrev_b32 v243, 5, v0
    v_lshl_or_b32 v229, v243, 30, v229
    v_mul_u32_u24 v243, 704, v243
    v_sub_u32 v226, v226, v243
    v_and_b32 v243, 15, v0
    v_mul_u32_u24 v243, 176, v243
    v_lshrrev_b32 v244, 4, v0
    v_lshl_add_u32 v243, v244, 3, v243
    v_add_u32 v253, s73, v243
    v_lshlrev_b32 v254, 7, v0
    v_lshrrev_b32 v243, 2, v0
    v_mul_u32_u24 v243, 160, v243
    v_and_b32 v244, 3, v0
    v_lshl_add_u32 v251, v244, 3, v243
    v_add_u32 v252, 119808, v251
    s_waitcnt vmcnt(0)
    s_mov_b32 s77, 0
L_rdy_34:
    v_readfirstlane_b32 s76, v249
    s_nop 2
    s_cmp_lg_u32 s76, 0
    s_cbranch_scc1 L_rdy_ok_35
    s_add_u32 s77, s77, 1
    s_cmp_gt_u32 s77, 20000
    s_cbranch_scc1 L_rdy_ok_35
    s_sleep 2
    buffer_load_dword v249, v248, s[40:43], 0 offen sc1
    s_waitcnt vmcnt(0)
    s_branch L_rdy_34
L_rdy_ok_35:
    v_mov_b32 v249, 1
    s_add_u32 s70, s68, 0
    s_cmp_ge_u32 s70, 819200
    s_cselect_b32 s71, 819200, 0
    s_sub_u32 s70, s70, s71
    s_add_u32 m0, s69, 119808
    s_nop 0
    buffer_load_dwordx4 v238, s[28:31], s70 offen lds
    s_add_u32 m0, s69, 120832
    s_nop 0
    buffer_load_dwordx4 v239, s[28:31], s70 offen lds
    s_add_u32 m0, s69, 121856
    s_nop 0
    buffer_load_dwordx4 v240, s[28:31], s70 offen lds
    s_add_u32 m0, s69, 122880
    s_nop 0
    buffer_load_dwordx4 v241, s[28:31], s70 offen lds
    s_add_u32 m0, s69, 123904
    s_nop 0
    buffer_load_dwordx4 v242, s[28:31], s70 offen lds
    s_waitcnt vmcnt(25)
    s_add_u32 s70, s68, 163840
    s_cmp_ge_u32 s70, 819200
    s_cselect_b32 s71, 819200, 0
    s_sub_u32 s70, s70, s71
    s_add_u32 m0, s69, 140288
    s_nop 0
    buffer_load_dwordx4 v238, s[28:31], s70 offen lds
    s_add_u32 m0, s69, 141312
    s_nop 0
    buffer_load_dwordx4 v239, s[28:31], s70 offen lds
    s_add_u32 m0, s69, 142336
    s_nop 0
    buffer_load_dwordx4 v240, s[28:31], s70 offen lds
    s_add_u32 m0, s69, 143360
    s_nop 0
    buffer_load_dwordx4 v241, s[28:31], s70 offen lds
    s_add_u32 m0, s69, 144384
    s_nop 0
    buffer_load_dwordx4 v242, s[28:31], s70 offen lds
    s_waitcnt vmcnt(25)
    v_mov_b32 v243, 118788
    v_mov_b32 v244, 1
    s_mov_b32 s77, 0
    s_waitcnt vmcnt(0)
    s_mov_b64 exec, 1
    ds_add_u32 v243, v244
L_rv_36:
    ds_read_b32 v244, v243
    s_add_u32 s77, s77, 1
    s_waitcnt lgkmcnt(0)
    v_cmp_gt_u32 vcc, 4, v244
    s_cbranch_vccz L_rv_ok_37
    s_sleep 1
    s_cmp_lt_u32 s77, 1000000
    s_cbranch_scc1 L_rv_36
L_rv_ok_37:
    s_mov_b64 exec, -1
    ds_read_b64_tr_b16 v[16:17], v252 offset:0
    ds_read_b64_tr_b16 v[18:19], v252 offset:2560
    ds_read_b64_tr_b16 v[20:21], v252 offset:32
    ds_read_b64_tr_b16 v[22:23], v252 offset:2592
    ds_read_b64_tr_b16 v[24:25], v252 offset:64
    ds_read_b64_tr_b16 v[26:27], v252 offset:2624
    ds_read_b64_tr_b16 v[28:29], v252 offset:96
    ds_read_b64_tr_b16 v[30:31], v252 offset:2656
    ds_read_b64_tr_b16 v[32:33], v252 offset:128
    ds_read_b64_tr_b16 v[34:35], v252 offset:2688
    ds_read_b64_tr_b16 v[36:37], v252 offset:5120
    ds_read_b64_tr_b16 v[38:39], v252 offset:7680
    ds_read_b64_tr_b16 v[40:41], v252 offset:5152
    ds_read_b64_tr_b16 v[42:43], v252 offset:7712
    ds_read_b64_tr_b16 v[44:45], v252 offset:5184
    ds_read_b64_tr_b16 v[46:47], v252 offset:7744
    ds_read_b64_tr_b16 v[48:49], v252 offset:5216
    ds_read_b64_tr_b16 v[50:51], v252 offset:7776
    ds_read_b64_tr_b16 v[52:53], v252 offset:5248
    ds_read_b64_tr_b16 v[54:55], v252 offset:7808
    ds_read_b64_tr_b16 v[56:57], v252 offset:10240
    ds_read_b64_tr_b16 v[58:59], v252 offset:12800
    ds_read_b64_tr_b16 v[60:61], v252 offset:10272
    ds_read_b64_tr_b16 v[62:63], v252 offset:12832
    ds_read_b64_tr_b16 v[64:65], v252 offset:10304
    ds_read_b64_tr_b16 v[66:67], v252 offset:12864
    ds_read_b64_tr_b16 v[68:69], v252 offset:10336
    ds_read_b64_tr_b16 v[70:71], v252 offset:12896
    ds_read_b64_tr_b16 v[72:73], v252 offset:10368
    ds_read_b64_tr_b16 v[74:75], v252 offset:12928
    ds_read_b64_tr_b16 v[76:77], v252 offset:15360
    ds_read_b64_tr_b16 v[78:79], v252 offset:17920
    ds_read_b64_tr_b16 v[80:81], v252 offset:15392
    ds_read_b64_tr_b16 v[82:83], v252 offset:17952
    ds_read_b64_tr_b16 v[84:85], v252 offset:15424
    ds_read_b64_tr_b16 v[86:87], v252 offset:17984
    ds_read_b64_tr_b16 v[88:89], v252 offset:15456
    ds_read_b64_tr_b16 v[90:91], v252 offset:18016
    ds_read_b64_tr_b16 v[92:93], v252 offset:15488
    ds_read_b64_tr_b16 v[94:95], v252 offset:18048
    ds_read_b64_tr_b16 v[96:97], v252 offset:20480
    ds_read_b64_tr_b16 v[98:99], v252 offset:23040
    ds_read_b64_tr_b16 v[100:101], v252 offset:20512
    ds_read_b64_tr_b16 v[102:103], v252 offset:23072
    ds_read_b64_tr_b16 v[104:105], v252 offset:20544
    ds_read_b64_tr_b16 v[106:107], v252 offset:23104
    ds_read_b64_tr_b16 v[108:109], v252 offset:20576
    ds_read_b64_tr_b16 v[110:111], v252 offset:23136
    ds_read_b64_tr_b16 v[112:113], v252 offset:20608
    ds_read_b64_tr_b16 v[114:115], v252 offset:23168
    ds_read_b64_tr_b16 v[144:145], v252 offset:25600
    ds_read_b64_tr_b16 v[146:147], v252 offset:28160
    ds_read_b64_tr_b16 v[148:149], v252 offset:25632
    ds_read_b64_tr_b16 v[150:151], v252 offset:28192
    ds_read_b64_tr_b16 v[152:153], v252 offset:25664
    ds_read_b64_tr_b16 v[154:155], v252 offset:28224
    ds_read_b64_tr_b16 v[156:157], v252 offset:25696
    ds_read_b64_tr_b16 v[158:159], v252 offset:28256
    ds_read_b64_tr_b16 v[160:161], v252 offset:25728
    ds_read_b64_tr_b16 v[162:163], v252 offset:28288
    ds_read_b64_tr_b16 v[164:165], v252 offset:30720
    ds_read_b64_tr_b16 v[166:167], v252 offset:33280
    ds_read_b64_tr_b16 v[168:169], v252 offset:30752
    ds_read_b64_tr_b16 v[170:171], v252 offset:33312
    ds_read_b64_tr_b16 v[172:173], v252 offset:30784
    ds_read_b64_tr_b16 v[174:175], v252 offset:33344
    ds_read_b64_tr_b16 v[176:177], v252 offset:30816
    ds_read_b64_tr_b16 v[178:179], v252 offset:33376
    ds_read_b64_tr_b16 v[180:181], v252 offset:30848
    ds_read_b64_tr_b16 v[182:183], v252 offset:33408
    ds_read_b64_tr_b16 v[116:117], v252 offset:35840
    ds_read_b64_tr_b16 v[118:119], v252 offset:38400
    ds_read_b64_tr_b16 v[120:121], v252 offset:35872
    ds_read_b64_tr_b16 v[122:123], v252 offset:38432
    ds_read_b64_tr_b16 v[124:125], v252 offset:35904
    ds_read_b64_tr_b16 v[126:127], v252 offset:38464
    ds_read_b64_tr_b16 v[128:129], v252 offset:35936
    ds_read_b64_tr_b16 v[130:131], v252 offset:38496
    ds_read_b64_tr_b16 v[132:133], v252 offset:35968
    ds_read_b64_tr_b16 v[134:135], v252 offset:38528
    s_add_u32 s70, s68, 327680
    s_cmp_ge_u32 s70, 819200
    s_cselect_b32 s71, 819200, 0
    s_sub_u32 s70, s70, s71
    s_add_u32 m0, s69, 0
    s_nop 0
    buffer_load_dwordx4 v238, s[28:31], s70 offen lds
    s_add_u32 m0, s69, 1024
    s_nop 0
    buffer_load_dwordx4 v239, s[28:31], s70 offen lds
    s_add_u32 m0, s69, 2048
    s_nop 0
    buffer_load_dwordx4 v240, s[28:31], s70 offen lds
    s_add_u32 m0, s69, 3072
    s_nop 0
    buffer_load_dwordx4 v241, s[28:31], s70 offen lds
    s_add_u32 m0, s69, 4096
    s_nop 0
    buffer_load_dwordx4 v242, s[28:31], s70 offen lds
    s_waitcnt vmcnt(25)
    v_mov_b32 v243, 118784
    s_mov_b32 s77, 0
L_y_38:
    ds_read_b128 v[244:247], v243
    s_add_u32 s77, s77, 1
    s_waitcnt lgkmcnt(0)
    v_cmp_gt_u32 vcc, 4, v244
    s_cbranch_vccz L_y_ok_39
    v_cmp_gt_u32 vcc, 14, v247
    s_cbranch_vccz L_y_ok_39
    s_sleep 2
    s_cmp_lt_u32 s77, 1000000
    s_cbranch_scc1 L_y_38
L_y_ok_39:
    s_add_u32 s70, s68, 491520
    s_cmp_ge_u32 s70, 819200
    s_cselect_b32 s71, 819200, 0
    s_sub_u32 s70, s70, s71
    s_add_u32 m0, s69, 20480
    s_nop 0
    buffer_load_dwordx4 v238, s[28:31], s70 offen lds
    s_add_u32 m0, s69, 21504
    s_nop 0
    buffer_load_dwordx4 v239, s[28:31], s70 offen lds
    s_add_u32 m0, s69, 22528
    s_nop 0
    buffer_load_dwordx4 v240, s[28:31], s70 offen lds
    s_add_u32 m0, s69, 23552
    s_nop 0
    buffer_load_dwordx4 v241, s[28:31], s70 offen lds
    s_add_u32 m0, s69, 24576
    s_nop 0
    buffer_load_dwordx4 v242, s[28:31], s70 offen lds
    s_waitcnt vmcnt(25)
    v_mov_b32 v243, 118784
    s_mov_b32 s77, 0
L_y_40:
    ds_read_b128 v[244:247], v243
    s_add_u32 s77, s77, 1
    s_waitcnt lgkmcnt(0)
    v_cmp_gt_u32 vcc, 4, v244
    s_cbranch_vccz L_y_ok_41
    v_cmp_gt_u32 vcc, 14, v247
    s_cbranch_vccz L_y_ok_41
    s_sleep 2
    s_cmp_lt_u32 s77, 1000000
    s_cbranch_scc1 L_y_40
L_y_ok_41:
    s_add_u32 s70, s68, 655360
    s_cmp_ge_u32 s70, 819200
    s_cselect_b32 s71, 819200, 0
    s_sub_u32 s70, s70, s71
    s_add_u32 m0, s69, 40960
    s_nop 0
    buffer_load_dwordx4 v238, s[28:31], s70 offen lds
    s_add_u32 m0, s69, 41984
    s_nop 0
    buffer_load_dwordx4 v239, s[28:31], s70 offen lds
    s_add_u32 m0, s69, 43008
    s_nop 0
    buffer_load_dwordx4 v240, s[28:31], s70 offen lds
    s_add_u32 m0, s69, 44032
    s_nop 0
    buffer_load_dwordx4 v241, s[28:31], s70 offen lds
    s_add_u32 m0, s69, 45056
    s_nop 0
    buffer_load_dwordx4 v242, s[28:31], s70 offen lds
    v_mov_b32 v243, 118788
    v_mov_b32 v244, 1
    s_mov_b32 s77, 0
    s_waitcnt vmcnt(0)
    s_mov_b64 exec, 1
    ds_add_u32 v243, v244
L_rv_42:
    ds_read_b32 v244, v243
    s_add_u32 s77, s77, 1
    s_waitcnt lgkmcnt(0)
    v_cmp_gt_u32 vcc, 8, v244
    s_cbranch_vccz L_rv_ok_43
    s_sleep 1
    s_cmp_lt_u32 s77, 1000000
    s_cbranch_scc1 L_rv_42
L_rv_ok_43:
    s_mov_b64 exec, -1
    s_branch L_A2
L_b2w_33:
    s_and_b32 s56, s18, 3
    s_lshl_b32 s72, s56, 9
    s_add_u32 s72, s72, s53
    s_and_b32 s73, s56, 1
    s_lshl_b32 s73, s73, 9
    s_lshr_b32 s74, s56, 1
    s_lshl_b32 s74, s74, 4
    s_add_u32 s73, s73, s74
    s_cmp_eq_u32 s53, 0
    s_cselect_b32 s55, s73, s72
    v_lshl_add_u32 v243, v1, 5, s55
    v_cvt_f32_u32 v243, v243
    v_mul_f32 v243, 0x3a000000, v243
    v_cvt_f32_u32 v247, v2
    v_mul_f32 v247, 4.0, v247
    v_mul_f32 v245, v243, v247
    v_add_f32 v246, 0x3e800000, v245
    v_fmamk_f32 v40, v243, 0x00000000, v245
    v_fmamk_f32 v41, v243, 0x3f800000, v245
    v_fmamk_f32 v42, v243, 0x40000000, v245
    v_fmamk_f32 v43, v243, 0x40400000, v245
    v_fmamk_f32 v44, v243, 0x41800000, v245
    v_fmamk_f32 v45, v243, 0x41880000, v245
    v_fmamk_f32 v46, v243, 0x41900000, v245
    v_fmamk_f32 v47, v243, 0x41980000, v245
    v_cos_f32 v40, v40
    v_cos_f32 v41, v41
    v_cos_f32 v42, v42
    v_cos_f32 v43, v43
    v_cos_f32 v44, v44
    v_cos_f32 v45, v45
    v_cos_f32 v46, v46
    v_cos_f32 v47, v47
    v_cvt_pk_bf16_f32 v4, v40, v41
    v_cvt_pk_bf16_f32 v5, v42, v43
    v_cvt_pk_bf16_f32 v6, v44, v45
    v_cvt_pk_bf16_f32 v7, v46, v47
    v_fmamk_f32 v40, v243, 0x42000000, v245
    v_fmamk_f32 v41, v243, 0x42040000, v245
    v_fmamk_f32 v42, v243, 0x42080000, v245
    v_fmamk_f32 v43, v243, 0x420c0000, v245
    v_fmamk_f32 v44, v243, 0x42400000, v245
    v_fmamk_f32 v45, v243, 0x42440000, v245
    v_fmamk_f32 v46, v243, 0x42480000, v245
    v_fmamk_f32 v47, v243, 0x424c0000, v245
    v_cos_f32 v40, v40
    v_cos_f32 v41, v41
    v_cos_f32 v42, v42
    v_cos_f32 v43, v43
    v_cos_f32 v44, v44
    v_cos_f32 v45, v45
    v_cos_f32 v46, v46
    v_cos_f32 v47, v47
    v_cvt_pk_bf16_f32 v8, v40, v41
    v_cvt_pk_bf16_f32 v9, v42, v43
    v_cvt_pk_bf16_f32 v10, v44, v45
    v_cvt_pk_bf16_f32 v11, v46, v47
    v_fmamk_f32 v40, v243, 0x00000000, v246
    v_fmamk_f32 v41, v243, 0x3f800000, v246
    v_fmamk_f32 v42, v243, 0x40000000, v246
    v_fmamk_f32 v43, v243, 0x40400000, v246
    v_fmamk_f32 v44, v243, 0x41800000, v246
    v_fmamk_f32 v45, v243, 0x41880000, v246
    v_fmamk_f32 v46, v243, 0x41900000, v246
    v_fmamk_f32 v47, v243, 0x41980000, v246
    v_cos_f32 v40, v40
    v_cos_f32 v41, v41
    v_cos_f32 v42, v42
    v_cos_f32 v43, v43
    v_cos_f32 v44, v44
    v_cos_f32 v45, v45
    v_cos_f32 v46, v46
    v_cos_f32 v47, v47
    v_cvt_pk_bf16_f32 v12, v40, v41
    v_cvt_pk_bf16_f32 v13, v42, v43
    v_cvt_pk_bf16_f32 v14, v44, v45
    v_cvt_pk_bf16_f32 v15, v46, v47
    v_fmamk_f32 v40, v243, 0x42000000, v246
    v_fmamk_f32 v41, v243, 0x42040000, v246
    v_fmamk_f32 v42, v243, 0x42080000, v246
    v_fmamk_f32 v43, v243, 0x420c0000, v246
    v_fmamk_f32 v44, v243, 0x42400000, v246
    v_fmamk_f32 v45, v243, 0x42440000, v246
    v_fmamk_f32 v46, v243, 0x42480000, v246
    v_fmamk_f32 v47, v243, 0x424c0000, v246
    v_cos_f32 v40, v40
    v_cos_f32 v41, v41
    v_cos_f32 v42, v42
    v_cos_f32 v43, v43
    v_cos_f32 v44, v44
    v_cos_f32 v45, v45
    v_cos_f32 v46, v46
    v_cos_f32 v47, v47
    v_cvt_pk_bf16_f32 v16, v40, v41
    v_cvt_pk_bf16_f32 v17, v42, v43
    v_cvt_pk_bf16_f32 v18, v44, v45
    v_cvt_pk_bf16_f32 v19, v46, v47
    v_mov_b32 v36, 0
    v_mov_b32 v37, 0
    v_mov_b32 v38, 0
    v_mov_b32 v39, 0
    s_cmp_eq_u32 s53, 0
    s_cbranch_scc1 L_k0_44
    v_mov_b32 v20, v4
    v_mov_b32 v21, v5
    v_mov_b32 v22, v6
    v_mov_b32 v23, v7
    v_mov_b32 v24, v8
    v_mov_b32 v25, v9
    v_mov_b32 v26, v10
    v_mov_b32 v27, v11
    v_mov_b32 v28, v12
    v_mov_b32 v29, v13
    v_mov_b32 v30, v14
    v_mov_b32 v31, v15
    v_mov_b32 v32, v16
    v_mov_b32 v33, v17
    v_mov_b32 v34, v18
    v_mov_b32 v35, v19
    s_branch L_kd_46
L_k0_44:
    s_cmp_ge_u32 s56, 2
    s_cbranch_scc1 L_k0hi_45
    v_mov_b32 v20, v12
    v_mov_b32 v12, 0
    v_mov_b32 v28, 0
    v_mov_b32 v21, v13
    v_mov_b32 v13, 0
    v_mov_b32 v29, 0
    v_mov_b32 v22, v14
    v_mov_b32 v14, 0
    v_mov_b32 v30, 0
    v_mov_b32 v23, v15
    v_mov_b32 v15, 0
    v_mov_b32 v31, 0
    v_mov_b32 v24, v16
    v_mov_b32 v16, 0
    v_mov_b32 v32, 0
    v_mov_b32 v25, v17
    v_mov_b32 v17, 0
    v_mov_b32 v33, 0
    v_mov_b32 v26, v18
    v_mov_b32 v18, 0
    v_mov_b32 v34, 0
    v_mov_b32 v27, v19
    v_mov_b32 v19, 0
    v_mov_b32 v35, 0
    v_or_b32 v243, s56, v1
    v_cmp_eq_u32 vcc, 0, v243
    v_mov_b32 v244, 0x3f80
    v_mov_b32 v245, 1.0
    v_cndmask_b32 v4, v4, v244, vcc
    v_cndmask_b32 v5, v5, v244, vcc
    v_cndmask_b32 v6, v6, v244, vcc
    v_cndmask_b32 v7, v7, v244, vcc
    v_cndmask_b32 v8, v8, v244, vcc
    v_cndmask_b32 v9, v9, v244, vcc
    v_cndmask_b32 v10, v10, v244, vcc
    v_cndmask_b32 v11, v11, v244, vcc
    v_cndmask_b32 v36, v36, v245, vcc
    v_cndmask_b32 v37, v37, v245, vcc
    v_cndmask_b32 v38, v38, v245, vcc
    v_cndmask_b32 v39, v39, v245, vcc
    s_branch L_kd_46
L_k0hi_45:
    v_mov_b32 v28, v12
    v_mov_b32 v12, v4
    v_mov_b32 v4, 0
    v_mov_b32 v20, 0
    v_mov_b32 v29, v13
    v_mov_b32 v13, v5
    v_mov_b32 v5, 0
    v_mov_b32 v21, 0
    v_mov_b32 v30, v14
    v_mov_b32 v14, v6
    v_mov_b32 v6, 0
    v_mov_b32 v22, 0
    v_mov_b32 v31, v15
    v_mov_b32 v15, v7
    v_mov_b32 v7, 0
    v_mov_b32 v23, 0
    v_mov_b32 v32, v16
    v_mov_b32 v16, v8
    v_mov_b32 v8, 0
    v_mov_b32 v24, 0
    v_mov_b32 v33, v17
    v_mov_b32 v17, v9
    v_mov_b32 v9, 0
    v_mov_b32 v25, 0
    v_mov_b32 v34, v18
    v_mov_b32 v18, v10
    v_mov_b32 v10, 0
    v_mov_b32 v26, 0
    v_mov_b32 v35, v19
    v_mov_b32 v19, v11
    v_mov_b32 v11, 0
    v_mov_b32 v27, 0
L_kd_46:
    v_lshrrev_b32 v243, 2, v0
    v_lshlrev_b32 v244, 5, v243
    v_add_u32 v201, 94208, v244
    v_and_b32 v244, 3, v0
    v_lshlrev_b32 v244, 3, v244
    v_lshl_add_u32 v244, v243, 7, v244
    v_add_u32 v244, 61440, v244
    v_bfe_u32 v245, v0, 3, 2
    v_xor_b32 v246, 0, v245
    v_lshl_add_u32 v214, v246, 5, v244
    v_xor_b32 v246, 1, v245
    v_lshl_add_u32 v215, v246, 5, v244
    v_xor_b32 v246, 2, v245
    v_lshl_add_u32 v216, v246, 5, v244
    v_xor_b32 v246, 3, v245
    v_lshl_add_u32 v217, v246, 5, v244
    v_lshlrev_b32 v243, 5, v2
    v_xor_b32 v218, v243, v250
    s_mul_i32 s72, s56, 2304
    s_add_u32 s72, s72, 98304
    v_mul_u32_u24 v243, 144, v1
    v_add_u32 v203, s72, v243
    v_lshl_add_u32 v202, v2, 4, v203
    v_lshrrev_b32 v243, 3, v0
    v_and_b32 v244, 7, v0
    v_mul_u32_u24 v245, 144, v243
    v_add_u32 v245, s72, v245
    v_lshl_add_u32 v204, v244, 4, v245
    v_xor_b32 v246, 7, v244
    v_lshl_add_u32 v205, v246, 4, v245
    s_lshl_b32 s72, s54, 7
    s_add_u32 s73, s72, 1280
    s_sub_u32 s74, 2432, s72
    s_movk_i32 s75, 2560
    v_lshlrev_b32 v244, 4, v244
    v_lshl_add_u32 v243, v243, 5, s55
    v_sub_u32 v245, 2048, v243
    v_and_b32 v245, 2047, v245
    v_mad_u32_u24 v246, v243, s75, v244
    v_mad_u32_u24 v247, v245, s75, v244
    v_cmp_eq_u32 vcc, 0, v243
    v_add_u32 v245, 2621440, v246
    v_add_u32 v209, s74, v246
    v_add_u32 v207, s73, v247
    v_cndmask_b32 v246, v246, v245, vcc
    v_cndmask_b32 v247, v247, v245, vcc
    v_add_u32 v206, s73, v246
    v_add_u32 v208, s74, v247
    v_add_u32 v243, 256, v243
    v_sub_u32 v245, 2048, v243
    v_and_b32 v245, 2047, v245
    v_mad_u32_u24 v246, v243, s75, v244
    v_mad_u32_u24 v247, v245, s75, v244
    v_add_u32 v210, s73, v246
    v_add_u32 v211, s73, v247
    v_add_u32 v212, s74, v247
    v_add_u32 v213, s74, v246
    s_mul_i32 s72, s53, 5
    s_add_u32 s72, s72, s54
    s_lshl_b32 s72, s72, 15
    s_add_u32 s72, s72, 3145728
    s_lshl_b32 s73, s56, 5
    v_lshrrev_b32 v243, 1, v0
    v_add_u32 v243, s73, v243
    v_and_b32 v244, 1, v0
    s_add_u32 s73, s72, 32768
    s_lshl_b32 s74, s53, 11
    s_add_u32 s74, s74, 6291456
    v_lshlrev_b32 v245, 6, v244
    v_lshl_add_u32 v245, v243, 7, v245
    v_add_u32 v245, s73, v245
    v_lshl_add_u32 v246, v243, 4, s74
    v_lshl_or_b32 v246, v244, 30, v246
    s_cmp_eq_u32 s54, 4
    s_cselect_b64 vcc, -1, 0
    v_cndmask_b32 v219, v245, v246, vcc
    s_lshl_b32 s74, s56, 13
    s_add_u32 s72, s72, s74
    s_add_u32 s74, s74, 61440
    s_lshl_b32 s75, s56, 10
    s_add_u32 s75, s75, 94208
    v_mov_b32 v41, 118796
    v_lshlrev_b32 v42, 2, v0
    s_mov_b32 s77, 0
    s_cmp_lg_u32 s18, 4
    s_cbranch_scc1 L_relay_49
    buffer_load_dword v249, v248, s[40:43], 0 offen sc1
    s_waitcnt vmcnt(0)
    s_mov_b32 s77, 0
L_rdy_51:
    v_readfirstlane_b32 s76, v249
    s_nop 2
    s_cmp_lg_u32 s76, 0
    s_cbranch_scc1 L_rdy_ok_52
    s_add_u32 s77, s77, 1
    s_cmp_gt_u32 s77, 20000
    s_cbranch_scc1 L_rdy_ok_52
    s_sleep 2
    buffer_load_dword v249, v248, s[40:43], 0 offen sc1
    s_waitcnt vmcnt(0)
    s_branch L_rdy_51
L_rdy_ok_52:
    v_mov_b32 v249, 1
    s_mov_b32 s77, 0
    v_lshlrev_b32 v42, 7, v0
    s_mov_b32 s73, 6840320
L_pollg_47:
    buffer_load_dword v40, v42, s[32:35], s73 offen sc1
    s_waitcnt vmcnt(0)
    v_cmp_ne_u32 vcc, 1, v40
    s_add_u32 s77, s77, 1
    s_cbranch_vccz L_pollg_ok_48
    s_nop 0
    s_bcnt1_i32_b64 s59, vcc
    s_add_u32 s59, s59, 2
    v_mov_b32 v40, s59
    ds_write_b32 v41, v40
    s_cmp_gt_u32 s77, 20000
    s_cbranch_scc1 L_pollg_ok_48
    s_sleep 8
    s_branch L_pollg_47
L_pollg_ok_48:
    v_mov_b32 v40, 1
    ds_write_b32 v41, v40
    s_branch L_relay_ok_50
L_relay_49:
    ds_read_b32 v40, v41
    s_add_u32 s77, s77, 1
    s_waitcnt lgkmcnt(0)
    v_cmp_ne_u32 vcc, 1, v40
    s_cbranch_vccz L_relay_ok_50
    s_sleep 3
    s_cmp_lt_u32 s77, 1000000
    s_cbranch_scc1 L_relay_49
L_relay_ok_50:
    s_mov_b64 exec, -1
    s_mov_b32 m0, s74
    s_nop 0
    buffer_load_dwordx4 v218, s[32:35], s72 offen offset:0 sc1 lds
    buffer_load_dwordx4 v218, s[32:35], s72 offen offset:1024 sc1 lds
    buffer_load_dwordx4 v218, s[32:35], s72 offen offset:2048 sc1 lds
    buffer_load_dwordx4 v218, s[32:35], s72 offen offset:3072 sc1 lds
    s_add_u32 m0, m0, 4096
    s_add_u32 s72, s72, 4096
    buffer_load_dwordx4 v218, s[32:35], s72 offen offset:0 sc1 lds
    buffer_load_dwordx4 v218, s[32:35], s72 offen offset:1024 sc1 lds
    buffer_load_dwordx4 v218, s[32:35], s72 offen offset:2048 sc1 lds
    buffer_load_dwordx4 v218, s[32:35], s72 offen offset:3072 sc1 lds
    s_mov_b32 m0, s75
    s_nop 0
    buffer_load_dwordx4 v219, s[32:35], 0 offen sc1 lds
    v_mov_b32 v243, 118784
    v_mov_b32 v244, 1
    s_mov_b64 exec, 1
    ds_add_u32 v243, v244
    s_mov_b64 exec, -1
    v_mov_b32 v243, 118792
    v_mov_b32 v244, 1
    s_mov_b32 s77, 0
    s_waitcnt vmcnt(0)
    s_mov_b64 exec, 1
    ds_add_u32 v243, v244
L_rv_53:
    ds_read_b32 v244, v243
    s_add_u32 s77, s77, 1
    s_waitcnt lgkmcnt(0)
    v_cmp_gt_u32 vcc, 4, v244
    s_cbranch_vccz L_rv_ok_54
    s_sleep 1
    s_cmp_lt_u32 s77, 1000000
    s_cbranch_scc1 L_rv_53
L_rv_ok_54:
    s_mov_b64 exec, -1
    ds_read_b64_tr_b16 v[80:81], v214 offset:0
    ds_read_b64_tr_b16 v[82:83], v214 offset:2048
    ds_read_b64_tr_b16 v[84:85], v215 offset:0
    ds_read_b64_tr_b16 v[86:87], v215 offset:2048
    ds_read_b64_tr_b16 v[88:89], v214 offset:16384
    ds_read_b64_tr_b16 v[90:91], v214 offset:18432
    ds_read_b64_tr_b16 v[92:93], v215 offset:16384
    ds_read_b64_tr_b16 v[94:95], v215 offset:18432
    ds_read_b64_tr_b16 v[96:97], v216 offset:0
    ds_read_b64_tr_b16 v[98:99], v216 offset:2048
    ds_read_b64_tr_b16 v[100:101], v217 offset:0
    ds_read_b64_tr_b16 v[102:103], v217 offset:2048
    ds_read_b64_tr_b16 v[104:105], v216 offset:16384
    ds_read_b64_tr_b16 v[106:107], v216 offset:18432
    ds_read_b64_tr_b16 v[108:109], v217 offset:16384
    ds_read_b64_tr_b16 v[110:111], v217 offset:18432
    ds_read_b64_tr_b16 v[112:113], v201 offset:0
    ds_read_b64_tr_b16 v[114:115], v201 offset:512
    ds_read_b64_tr_b16 v[116:117], v201 offset:16
    ds_read_b64_tr_b16 v[118:119], v201 offset:528
    s_waitcnt lgkmcnt(15)
    v_mfma_f32_16x16x32_bf16 v[40:43], v[80:83], v[4:7], 0
    ds_read_b64_tr_b16 v[120:121], v214 offset:4096
    ds_read_b64_tr_b16 v[122:123], v214 offset:6144
    s_waitcnt lgkmcnt(15)
    v_mfma_f32_16x16x32_bf16 v[44:47], v[84:87], v[4:7], 0
    ds_read_b64_tr_b16 v[124:125], v215 offset:4096
    ds_read_b64_tr_b16 v[126:127], v215 offset:6144
    s_waitcnt lgkmcnt(15)
    v_mfma_f32_16x16x32_bf16 v[48:51], v[88:91], v[4:7], 0
    ds_read_b64_tr_b16 v[128:129], v214 offset:20480
    ds_read_b64_tr_b16 v[130:131], v214 offset:22528
    s_waitcnt lgkmcnt(15)
    v_mfma_f32_16x16x32_bf16 v[52:55], v[92:95], v[4:7], 0
    ds_read_b64_tr_b16 v[132:133], v215 offset:20480
    ds_read_b64_tr_b16 v[134:135], v215 offset:22528
    s_waitcnt lgkmcnt(15)
    v_mfma_f32_16x16x32_bf16 v[56:59], v[96:99], v[20:23], 0
    ds_read_b64_tr_b16 v[136:137], v216 offset:4096
    ds_read_b64_tr_b16 v[138:139], v216 offset:6144
    s_waitcnt lgkmcnt(15)
    v_mfma_f32_16x16x32_bf16 v[60:63], v[100:103], v[20:23], 0
    ds_read_b64_tr_b16 v[140:141], v217 offset:4096
    ds_read_b64_tr_b16 v[142:143], v217 offset:6144
    s_waitcnt lgkmcnt(15)
    v_mfma_f32_16x16x32_bf16 v[64:67], v[104:107], v[20:23], 0
    ds_read_b64_tr_b16 v[144:145], v216 offset:20480
    ds_read_b64_tr_b16 v[146:147], v216 offset:22528
    s_waitcnt lgkmcnt(15)
    v_mfma_f32_16x16x32_bf16 v[68:71], v[108:111], v[20:23], 0
    ds_read_b64_tr_b16 v[148:149], v217 offset:20480
    ds_read_b64_tr_b16 v[150:151], v217 offset:22528
    s_waitcnt lgkmcnt(15)
    v_mfma_f32_16x16x32_bf16 v[72:75], v[112:115], v[4:7], 0
    ds_read_b64_tr_b16 v[152:153], v201 offset:1024
    ds_read_b64_tr_b16 v[154:155], v201 offset:1536
    s_waitcnt lgkmcnt(15)
    v_mfma_f32_16x16x32_bf16 v[76:79], v[116:119], v[20:23], 0
    ds_read_b64_tr_b16 v[156:157], v201 offset:1040
    ds_read_b64_tr_b16 v[158:159], v201 offset:1552
    s_waitcnt lgkmcnt(15)
    v_mfma_f32_16x16x32_bf16 v[40:43], v[120:123], v[8:11], v[40:43]
    ds_read_b64_tr_b16 v[80:81], v214 offset:8192
    ds_read_b64_tr_b16 v[82:83], v214 offset:10240
    s_waitcnt lgkmcnt(15)
    v_mfma_f32_16x16x32_bf16 v[44:47], v[124:127], v[8:11], v[44:47]
    ds_read_b64_tr_b16 v[84:85], v215 offset:8192
    ds_read_b64_tr_b16 v[86:87], v215 offset:10240
    s_waitcnt lgkmcnt(15)
    v_mfma_f32_16x16x32_bf16 v[48:51], v[128:131], v[8:11], v[48:51]
    ds_read_b64_tr_b16 v[88:89], v214 offset:24576
    ds_read_b64_tr_b16 v[90:91], v214 offset:26624
    s_waitcnt lgkmcnt(15)
    v_mfma_f32_16x16x32_bf16 v[52:55], v[132:135], v[8:11], v[52:55]
    ds_read_b64_tr_b16 v[92:93], v215 offset:24576
    ds_read_b64_tr_b16 v[94:95], v215 offset:26624
    s_waitcnt lgkmcnt(15)
    v_mfma_f32_16x16x32_bf16 v[56:59], v[136:139], v[24:27], v[56:59]
    ds_read_b64_tr_b16 v[96:97], v216 offset:8192
    ds_read_b64_tr_b16 v[98:99], v216 offset:10240
    s_waitcnt lgkmcnt(15)
    v_mfma_f32_16x16x32_bf16 v[60:63], v[140:143], v[24:27], v[60:63]
    ds_read_b64_tr_b16 v[100:101], v217 offset:8192
    ds_read_b64_tr_b16 v[102:103], v217 offset:10240
    s_waitcnt lgkmcnt(15)
    v_mfma_f32_16x16x32_bf16 v[64:67], v[144:147], v[24:27], v[64:67]
    ds_read_b64_tr_b16 v[104:105], v216 offset:24576
    ds_read_b64_tr_b16 v[106:107], v216 offset:26624
    s_waitcnt lgkmcnt(15)
    v_mfma_f32_16x16x32_bf16 v[68:71], v[148:151], v[24:27], v[68:71]
    ds_read_b64_tr_b16 v[108:109], v217 offset:24576
    ds_read_b64_tr_b16 v[110:111], v217 offset:26624
    s_waitcnt lgkmcnt(15)
    v_mfma_f32_16x16x32_bf16 v[72:75], v[152:155], v[8:11], v[72:75]
    ds_read_b64_tr_b16 v[112:113], v201 offset:2048
    ds_read_b64_tr_b16 v[114:115], v201 offset:2560
    s_waitcnt lgkmcnt(15)
    v_mfma_f32_16x16x32_bf16 v[76:79], v[156:159], v[24:27], v[76:79]
    ds_read_b64_tr_b16 v[116:117], v201 offset:2064
    ds_read_b64_tr_b16 v[118:119], v201 offset:2576
    s_waitcnt lgkmcnt(15)
    v_mfma_f32_16x16x32_bf16 v[40:43], v[80:83], v[12:15], v[40:43]
    ds_read_b64_tr_b16 v[120:121], v214 offset:12288
    ds_read_b64_tr_b16 v[122:123], v214 offset:14336
    s_waitcnt lgkmcnt(15)
    v_mfma_f32_16x16x32_bf16 v[44:47], v[84:87], v[12:15], v[44:47]
    ds_read_b64_tr_b16 v[124:125], v215 offset:12288
    ds_read_b64_tr_b16 v[126:127], v215 offset:14336
    s_waitcnt lgkmcnt(15)
    v_mfma_f32_16x16x32_bf16 v[48:51], v[88:91], v[12:15], v[48:51]
    ds_read_b64_tr_b16 v[128:129], v214 offset:28672
    ds_read_b64_tr_b16 v[130:131], v214 offset:30720
    s_waitcnt lgkmcnt(15)
    v_mfma_f32_16x16x32_bf16 v[52:55], v[92:95], v[12:15], v[52:55]
    ds_read_b64_tr_b16 v[132:133], v215 offset:28672
    ds_read_b64_tr_b16 v[134:135], v215 offset:30720
    s_waitcnt lgkmcnt(15)
    v_mfma_f32_16x16x32_bf16 v[56:59], v[96:99], v[28:31], v[56:59]
    ds_read_b64_tr_b16 v[136:137], v216 offset:12288
    ds_read_b64_tr_b16 v[138:139], v216 offset:14336
    s_waitcnt lgkmcnt(15)
    v_mfma_f32_16x16x32_bf16 v[60:63], v[100:103], v[28:31], v[60:63]
    ds_read_b64_tr_b16 v[140:141], v217 offset:12288
    ds_read_b64_tr_b16 v[142:143], v217 offset:14336
    s_waitcnt lgkmcnt(15)
    v_mfma_f32_16x16x32_bf16 v[64:67], v[104:107], v[28:31], v[64:67]
    ds_read_b64_tr_b16 v[144:145], v216 offset:28672
    ds_read_b64_tr_b16 v[146:147], v216 offset:30720
    s_waitcnt lgkmcnt(15)
    v_mfma_f32_16x16x32_bf16 v[68:71], v[108:111], v[28:31], v[68:71]
    ds_read_b64_tr_b16 v[148:149], v217 offset:28672
    ds_read_b64_tr_b16 v[150:151], v217 offset:30720
    s_waitcnt lgkmcnt(15)
    v_mfma_f32_16x16x32_bf16 v[72:75], v[112:115], v[12:15], v[72:75]
    ds_read_b64_tr_b16 v[152:153], v201 offset:3072
    ds_read_b64_tr_b16 v[154:155], v201 offset:3584
    s_waitcnt lgkmcnt(15)
    v_mfma_f32_16x16x32_bf16 v[76:79], v[116:119], v[28:31], v[76:79]
    ds_read_b64_tr_b16 v[156:157], v201 offset:3088
    ds_read_b64_tr_b16 v[158:159], v201 offset:3600
    s_waitcnt lgkmcnt(15)
    v_mfma_f32_16x16x32_bf16 v[40:43], v[120:123], v[16:19], v[40:43]
    s_waitcnt lgkmcnt(15)
    v_mfma_f32_16x16x32_bf16 v[44:47], v[124:127], v[16:19], v[44:47]
    s_waitcnt lgkmcnt(14)
    v_mfma_f32_16x16x32_bf16 v[48:51], v[128:131], v[16:19], v[48:51]
    s_waitcnt lgkmcnt(12)
    v_mfma_f32_16x16x32_bf16 v[52:55], v[132:135], v[16:19], v[52:55]
    s_waitcnt lgkmcnt(10)
    v_mfma_f32_16x16x32_bf16 v[56:59], v[136:139], v[32:35], v[56:59]
    s_waitcnt lgkmcnt(8)
    v_mfma_f32_16x16x32_bf16 v[60:63], v[140:143], v[32:35], v[60:63]
    s_waitcnt lgkmcnt(6)
    v_mfma_f32_16x16x32_bf16 v[64:67], v[144:147], v[32:35], v[64:67]
    s_waitcnt lgkmcnt(4)
    v_mfma_f32_16x16x32_bf16 v[68:71], v[148:151], v[32:35], v[68:71]
    s_waitcnt lgkmcnt(2)
    v_mfma_f32_16x16x32_bf16 v[72:75], v[152:155], v[16:19], v[72:75]
    s_waitcnt lgkmcnt(0)
    v_mfma_f32_16x16x32_bf16 v[76:79], v[156:159], v[32:35], v[76:79]
    s_cmp_lg_u32 s55, 0
    s_cbranch_scc1 L_nox0_55
    ds_read_b64_tr_b16 v[80:81], v214 offset:0
    ds_read_b64_tr_b16 v[82:83], v214 offset:2048
    ds_read_b64_tr_b16 v[84:85], v215 offset:0
    ds_read_b64_tr_b16 v[86:87], v215 offset:2048
    ds_read_b64_tr_b16 v[88:89], v214 offset:16384
    ds_read_b64_tr_b16 v[90:91], v214 offset:18432
    ds_read_b64_tr_b16 v[92:93], v215 offset:16384
    ds_read_b64_tr_b16 v[94:95], v215 offset:18432
    ds_read_b64_tr_b16 v[112:113], v201 offset:0
    ds_read_b64_tr_b16 v[114:115], v201 offset:512
    ds_read_b64_tr_b16 v[120:121], v214 offset:4096
    ds_read_b64_tr_b16 v[122:123], v214 offset:6144
    ds_read_b64_tr_b16 v[124:125], v215 offset:4096
    ds_read_b64_tr_b16 v[126:127], v215 offset:6144
    ds_read_b64_tr_b16 v[128:129], v214 offset:20480
    ds_read_b64_tr_b16 v[130:131], v214 offset:22528
    ds_read_b64_tr_b16 v[132:133], v215 offset:20480
    ds_read_b64_tr_b16 v[134:135], v215 offset:22528
    ds_read_b64_tr_b16 v[152:153], v201 offset:1024
    ds_read_b64_tr_b16 v[154:155], v201 offset:1536
    s_waitcnt lgkmcnt(0)
    v_mfma_f32_16x16x32_bf16 v[56:59], v[80:83], v[36:39], v[56:59]
    v_mfma_f32_16x16x32_bf16 v[60:63], v[84:87], v[36:39], v[60:63]
    v_mfma_f32_16x16x32_bf16 v[64:67], v[88:91], v[36:39], v[64:67]
    v_mfma_f32_16x16x32_bf16 v[68:71], v[92:95], v[36:39], v[68:71]
    v_mfma_f32_16x16x32_bf16 v[76:79], v[112:115], v[36:39], v[76:79]
    v_mfma_f32_16x16x32_bf16 v[56:59], v[120:123], v[36:39], v[56:59]
    v_mfma_f32_16x16x32_bf16 v[60:63], v[124:127], v[36:39], v[60:63]
    v_mfma_f32_16x16x32_bf16 v[64:67], v[128:131], v[36:39], v[64:67]
    v_mfma_f32_16x16x32_bf16 v[68:71], v[132:135], v[36:39], v[68:71]
    v_mfma_f32_16x16x32_bf16 v[76:79], v[152:155], v[36:39], v[76:79]
    s_nop 7
L_nox0_55:
    s_mov_b32 s72, 0xffff
    v_pk_add_f32 v[80:81], v[40:41], v[56:57] neg_lo:[0,1] neg_hi:[0,1]
    v_pk_add_f32 v[84:85], v[48:49], v[64:65] neg_lo:[0,1] neg_hi:[0,1]
    v_pk_add_f32 v[82:83], v[42:43], v[58:59] neg_lo:[0,1] neg_hi:[0,1]
    v_pk_add_f32 v[86:87], v[50:51], v[66:67] neg_lo:[0,1] neg_hi:[0,1]
    v_cvt_pk_bf16_f32 v88, v80, v84
    v_cvt_pk_bf16_f32 v89, v81, v85
    v_cvt_pk_bf16_f32 v90, v82, v86
    v_cvt_pk_bf16_f32 v91, v83, v87
    ds_write_b128 v202, v[88:91] offset:0
    v_pk_add_f32 v[92:93], v[44:45], v[60:61] neg_lo:[0,1] neg_hi:[0,1]
    v_pk_add_f32 v[96:97], v[52:53], v[68:69] neg_lo:[0,1] neg_hi:[0,1]
    v_pk_add_f32 v[94:95], v[46:47], v[62:63] neg_lo:[0,1] neg_hi:[0,1]
    v_pk_add_f32 v[98:99], v[54:55], v[70:71] neg_lo:[0,1] neg_hi:[0,1]
    v_cvt_pk_bf16_f32 v100, v92, v96
    v_cvt_pk_bf16_f32 v101, v93, v97
    v_cvt_pk_bf16_f32 v102, v94, v98
    v_cvt_pk_bf16_f32 v103, v95, v99
    ds_write_b128 v202, v[100:103] offset:64
    v_sub_f32 v130, v72, v76
    v_cvt_pk_bf16_f32 v130, v130, v130
    ds_write_b32 v203, v130 offset:128
    ds_read_b128 v[132:135], v204 offset:0
    ds_read_b128 v[136:139], v205 offset:0
    ds_read_b32 v140, v205 offset:16
    ds_read_b128 v[152:155], v204 offset:1152
    ds_read_b128 v[156:159], v205 offset:1152
    ds_read_b32 v160, v205 offset:1168
    v_pk_add_f32 v[104:105], v[40:41], v[56:57]
    v_pk_add_f32 v[108:109], v[48:49], v[64:65]
    v_pk_add_f32 v[106:107], v[42:43], v[58:59]
    v_pk_add_f32 v[110:111], v[50:51], v[66:67]
    v_cvt_pk_bf16_f32 v112, v104, v108
    v_cvt_pk_bf16_f32 v113, v105, v109
    v_cvt_pk_bf16_f32 v114, v106, v110
    v_cvt_pk_bf16_f32 v115, v107, v111
    ds_write_b128 v202, v[112:115] offset:0
    v_pk_add_f32 v[116:117], v[44:45], v[60:61]
    v_pk_add_f32 v[120:121], v[52:53], v[68:69]
    v_pk_add_f32 v[118:119], v[46:47], v[62:63]
    v_pk_add_f32 v[122:123], v[54:55], v[70:71]
    v_cvt_pk_bf16_f32 v124, v116, v120
    v_cvt_pk_bf16_f32 v125, v117, v121
    v_cvt_pk_bf16_f32 v126, v118, v122
    v_cvt_pk_bf16_f32 v127, v119, v123
    ds_write_b128 v202, v[124:127] offset:64
    v_add_f32 v131, v72, v76
    v_cvt_pk_bf16_f32 v131, v131, v131
    ds_write_b32 v203, v131 offset:128
    ds_read_b128 v[142:145], v204 offset:0
    ds_read_b128 v[146:149], v205 offset:0
    ds_read_b32 v150, v205 offset:16
    ds_read_b128 v[162:165], v204 offset:1152
    ds_read_b128 v[166:169], v205 offset:1152
    ds_read_b32 v170, v205 offset:1168
    s_waitcnt lgkmcnt(14)
    buffer_store_dwordx4 v[132:135], v206, s[36:39], 0 offen sc1
    s_waitcnt lgkmcnt(12)
    v_bfi_b32 v176, s72, v140, v139
    v_bfi_b32 v177, s72, v139, v138
    v_bfi_b32 v178, s72, v138, v137
    v_bfi_b32 v179, s72, v137, v136
    buffer_store_dwordx4 v[176:179], v208, s[36:39], 0 offen sc1
    s_waitcnt lgkmcnt(11)
    buffer_store_dwordx4 v[152:155], v210, s[36:39], 0 offen sc1
    s_waitcnt lgkmcnt(9)
    v_bfi_b32 v184, s72, v160, v159
    v_bfi_b32 v185, s72, v159, v158
    v_bfi_b32 v186, s72, v158, v157
    v_bfi_b32 v187, s72, v157, v156
    buffer_store_dwordx4 v[184:187], v212, s[36:39], 0 offen sc1
    s_waitcnt lgkmcnt(5)
    buffer_store_dwordx4 v[142:145], v207, s[36:39], 0 offen sc1
    s_waitcnt lgkmcnt(3)
    v_bfi_b32 v180, s72, v150, v149
    v_bfi_b32 v181, s72, v149, v148
    v_bfi_b32 v182, s72, v148, v147
    v_bfi_b32 v183, s72, v147, v146
    buffer_store_dwordx4 v[180:183], v209, s[36:39], 0 offen sc1
    s_waitcnt lgkmcnt(2)
    buffer_store_dwordx4 v[162:165], v211, s[36:39], 0 offen sc1
    s_waitcnt lgkmcnt(0)
    v_bfi_b32 v188, s72, v170, v169
    v_bfi_b32 v189, s72, v169, v168
    v_bfi_b32 v190, s72, v168, v167
    v_bfi_b32 v191, s72, v167, v166
    buffer_store_dwordx4 v[188:191], v213, s[36:39], 0 offen sc1
    s_endpgm
L_load2:
    s_setprio 0
    s_mov_b32 s28, s8
    s_and_b32 s29, s9, 0xffff
    s_mov_b32 s30, 819200
    s_mov_b32 s31, 0x20000
    s_mov_b32 s36, s12
    s_and_b32 s37, s13, 0xffff
    s_mov_b32 s38, 5242880
    s_mov_b32 s39, 0x20000
    v_mov_b32 v248, 0
    v_mov_b32 v254, 0
    v_bfrev_b32 v227, 1
    v_bfrev_b32 v228, 1
    v_bfrev_b32 v229, 1
    s_add_u32 s4, s4, 128
    s_cmp_eq_u32 s4, 768
    s_cselect_b32 s4, 0, s4
    s_cbranch_vccnz L_xs_13
    s_add_u32 m0, s3, 12288
    s_add_u32 s71, s99, s4
    buffer_load_dwordx4 v4, s[20:23], s71 offen lds
L_xs_13:
    s_add_u32 m0, s3, 0
    s_add_u32 s71, s96, s4
    buffer_load_dwordx4 v4, s[20:23], s71 offen lds
    s_add_u32 m0, s3, 4096
    s_add_u32 s71, s97, s4
    buffer_load_dwordx4 v4, s[20:23], s71 offen lds
    s_add_u32 m0, s3, 8192
    s_add_u32 s71, s98, s4
    buffer_load_dwordx4 v4, s[20:23], s71 offen lds
    s_add_u32 s3, s3, 14336
    s_cmp_ge_u32 s3, 119808
    s_cselect_b32 s71, 43008, 0
    s_sub_u32 s3, s3, s71
    s_mul_i32 s70, s4, 1920
    s_add_u32 m0, s5, 0
    s_nop 0
    buffer_load_dwordx4 v8, s[24:27], s70 offen lds
    s_add_u32 m0, s5, 1024
    s_nop 0
    buffer_load_dwordx4 v9, s[24:27], s70 offen lds
    s_add_u32 m0, s5, 2048
    s_nop 0
    buffer_load_dwordx4 v10, s[24:27], s70 offen lds
    s_add_u32 m0, s5, 3072
    s_mov_b64 exec, s[86:87]
    buffer_load_dwordx4 v11, s[24:27], s70 offen lds
    s_mov_b64 exec, -1
    s_add_u32 s5, s5, 15360
    s_cmp_ge_u32 s5, 76800
    s_cselect_b32 s71, 76800, 0
    s_sub_u32 s5, s5, s71
    s_waitcnt vmcnt(11)
    s_barrier
    s_add_u32 s70, s70, 122880
    s_add_u32 m0, s5, 0
    s_nop 0
    buffer_load_dwordx4 v8, s[24:27], s70 offen lds
    s_add_u32 m0, s5, 1024
    s_nop 0
    buffer_load_dwordx4 v9, s[24:27], s70 offen lds
    s_add_u32 m0, s5, 2048
    s_nop 0
    buffer_load_dwordx4 v10, s[24:27], s70 offen lds
    s_add_u32 m0, s5, 3072
    s_mov_b64 exec, s[86:87]
    buffer_load_dwordx4 v11, s[24:27], s70 offen lds
    s_mov_b64 exec, -1
    s_add_u32 s5, s5, 15360
    s_cmp_ge_u32 s5, 76800
    s_cselect_b32 s71, 76800, 0
    s_sub_u32 s5, s5, s71
    s_waitcnt vmcnt(11)
    s_barrier
    s_add_u32 s4, s4, 128
    s_cmp_eq_u32 s4, 768
    s_cselect_b32 s4, 0, s4
    s_cbranch_vccnz L_xs_14
    s_add_u32 m0, s3, 12288
    s_add_u32 s71, s99, s4
    buffer_load_dwordx4 v4, s[20:23], s71 offen lds
L_xs_14:
    s_add_u32 m0, s3, 0
    s_add_u32 s71, s96, s4
    buffer_load_dwordx4 v4, s[20:23], s71 offen lds
    s_add_u32 m0, s3, 4096
    s_add_u32 s71, s97, s4
    buffer_load_dwordx4 v4, s[20:23], s71 offen lds
    s_add_u32 m0, s3, 8192
    s_add_u32 s71, s98, s4
    buffer_load_dwordx4 v4, s[20:23], s71 offen lds
    s_add_u32 s3, s3, 14336
    s_cmp_ge_u32 s3, 119808
    s_cselect_b32 s71, 43008, 0
    s_sub_u32 s3, s3, s71
    s_mul_i32 s70, s4, 1920
    s_add_u32 m0, s5, 0
    s_nop 0
    buffer_load_dwordx4 v8, s[24:27], s70 offen lds
    s_add_u32 m0, s5, 1024
    s_nop 0
    buffer_load_dwordx4 v9, s[24:27], s70 offen lds
    s_add_u32 m0, s5, 2048
    s_nop 0
    buffer_load_dwordx4 v10, s[24:27], s70 offen lds
    s_add_u32 m0, s5, 3072
    s_mov_b64 exec, s[86:87]
    buffer_load_dwordx4 v11, s[24:27], s70 offen lds
    s_mov_b64 exec, -1
    s_add_u32 s5, s5, 15360
    s_cmp_ge_u32 s5, 76800
    s_cselect_b32 s71, 76800, 0
    s_sub_u32 s5, s5, s71
    s_add_u32 s70, s70, 122880
    s_add_u32 m0, s5, 0
    s_nop 0
    buffer_load_dwordx4 v8, s[24:27], s70 offen lds
    s_add_u32 m0, s5, 1024
    s_nop 0
    buffer_load_dwordx4 v9, s[24:27], s70 offen lds
    s_add_u32 m0, s5, 2048
    s_nop 0
    buffer_load_dwordx4 v10, s[24:27], s70 offen lds
    s_add_u32 m0, s5, 3072
    s_mov_b64 exec, s[86:87]
    buffer_load_dwordx4 v11, s[24:27], s70 offen lds
    s_mov_b64 exec, -1
    s_add_u32 s5, s5, 15360
    s_cmp_ge_u32 s5, 76800
    s_cselect_b32 s71, 76800, 0
    s_sub_u32 s5, s5, s71
    s_waitcnt vmcnt(15)
    s_barrier
    s_add_u32 s4, s4, 128
    s_cmp_eq_u32 s4, 768
    s_cselect_b32 s4, 0, s4
    s_cbranch_vccnz L_xs_15
    s_add_u32 m0, s3, 12288
    s_add_u32 s71, s99, s4
    buffer_load_dwordx4 v4, s[20:23], s71 offen lds
L_xs_15:
    s_add_u32 m0, s3, 0
    s_add_u32 s71, s96, s4
    buffer_load_dwordx4 v4, s[20:23], s71 offen lds
    s_mul_i32 s70, s4, 1920
    s_add_u32 m0, s5, 0
    s_nop 0
    buffer_load_dwordx4 v8, s[24:27], s70 offen lds
    s_add_u32 m0, s5, 1024
    s_nop 0
    buffer_load_dwordx4 v9, s[24:27], s70 offen lds
    s_add_u32 m0, s5, 2048
    s_nop 0
    buffer_load_dwordx4 v10, s[24:27], s70 offen lds
    s_add_u32 m0, s5, 3072
    s_mov_b64 exec, s[86:87]
    buffer_load_dwordx4 v11, s[24:27], s70 offen lds
    s_mov_b64 exec, -1
    s_add_u32 s5, s5, 15360
    s_cmp_ge_u32 s5, 76800
    s_cselect_b32 s71, 76800, 0
    s_sub_u32 s5, s5, s71
    s_waitcnt vmcnt(16)
    s_barrier
    s_add_u32 m0, s3, 4096
    s_add_u32 s71, s97, s4
    buffer_load_dwordx4 v4, s[20:23], s71 offen lds
    s_add_u32 m0, s3, 8192
    s_add_u32 s71, s98, s4
    buffer_load_dwordx4 v4, s[20:23], s71 offen lds
    s_add_u32 s3, s3, 14336
    s_cmp_ge_u32 s3, 119808
    s_cselect_b32 s71, 43008, 0
    s_sub_u32 s3, s3, s71
    s_add_u32 s70, s70, 122880
    s_add_u32 m0, s5, 0
    s_nop 0
    buffer_load_dwordx4 v8, s[24:27], s70 offen lds
    s_add_u32 m0, s5, 1024
    s_nop 0
    buffer_load_dwordx4 v9, s[24:27], s70 offen lds
    s_add_u32 m0, s5, 2048
    s_nop 0
    buffer_load_dwordx4 v10, s[24:27], s70 offen lds
    s_add_u32 m0, s5, 3072
    s_mov_b64 exec, s[86:87]
    buffer_load_dwordx4 v11, s[24:27], s70 offen lds
    s_mov_b64 exec, -1
    s_add_u32 s5, s5, 15360
    s_cmp_ge_u32 s5, 76800
    s_cselect_b32 s71, 76800, 0
    s_sub_u32 s5, s5, s71
    s_waitcnt vmcnt(15)
    s_barrier
    s_add_u32 s4, s4, 128
    s_cmp_eq_u32 s4, 768
    s_cselect_b32 s4, 0, s4
    s_cbranch_vccnz L_xs_16
    s_add_u32 m0, s3, 12288
    s_add_u32 s71, s99, s4
    buffer_load_dwordx4 v4, s[20:23], s71 offen lds
L_xs_16:
    s_add_u32 m0, s3, 0
    s_add_u32 s71, s96, s4
    buffer_load_dwordx4 v4, s[20:23], s71 offen lds
    s_mul_i32 s70, s4, 1920
    s_add_u32 m0, s5, 0
    s_nop 0
    buffer_load_dwordx4 v8, s[24:27], s70 offen lds
    s_add_u32 m0, s5, 1024
    s_nop 0
    buffer_load_dwordx4 v9, s[24:27], s70 offen lds
    s_add_u32 m0, s5, 2048
    s_nop 0
    buffer_load_dwordx4 v10, s[24:27], s70 offen lds
    s_add_u32 m0, s5, 3072
    s_mov_b64 exec, s[86:87]
    buffer_load_dwordx4 v11, s[24:27], s70 offen lds
    s_mov_b64 exec, -1
    s_add_u32 s5, s5, 15360
    s_cmp_ge_u32 s5, 76800
    s_cselect_b32 s71, 76800, 0
    s_sub_u32 s5, s5, s71
    s_waitcnt vmcnt(16)
    s_barrier
    s_add_u32 m0, s3, 4096
    s_add_u32 s71, s97, s4
    buffer_load_dwordx4 v4, s[20:23], s71 offen lds
    s_add_u32 m0, s3, 8192
    s_add_u32 s71, s98, s4
    buffer_load_dwordx4 v4, s[20:23], s71 offen lds
    s_add_u32 s3, s3, 14336
    s_cmp_ge_u32 s3, 119808
    s_cselect_b32 s71, 43008, 0
    s_sub_u32 s3, s3, s71
    s_mov_b32 s32, s16
    s_and_b32 s33, s17, 0xffff
    s_mov_b32 s34, 8388608
    s_mov_b32 s35, 0x20000
    s_mov_b32 s40, s14
    s_and_b32 s41, s15, 0xffff
    s_mov_b32 s42, 256
    s_mov_b32 s43, 0x20000
    s_and_b32 s66, s19, 7
    s_and_b32 s72, s2, 7
    s_lshl_b32 s72, s72, 2
    s_lshr_b32 s73, s19, 3
    s_add_u32 s72, s72, s73
    s_add_u32 s72, s72, s66
    s_mul_i32 s73, s72, 52
    s_add_u32 s70, s70, 122880
    s_add_u32 m0, s5, 0
    s_nop 0
    buffer_load_dwordx4 v8, s[24:27], s70 offen lds
    s_add_u32 m0, s5, 1024
    s_nop 0
    buffer_load_dwordx4 v9, s[24:27], s70 offen lds
    s_add_u32 m0, s5, 2048
    s_nop 0
    buffer_load_dwordx4 v10, s[24:27], s70 offen lds
    s_add_u32 m0, s5, 3072
    s_mov_b64 exec, s[86:87]
    buffer_load_dwordx4 v11, s[24:27], s70 offen lds
    s_mov_b64 exec, -1
    s_add_u32 s5, s5, 15360
    s_cmp_ge_u32 s5, 76800
    s_cselect_b32 s71, 76800, 0
    s_sub_u32 s5, s5, s71
    s_waitcnt vmcnt(15)
    s_barrier
    s_add_u32 s4, s4, 128
    s_cmp_eq_u32 s4, 768
    s_cselect_b32 s4, 0, s4
    s_cbranch_vccnz L_xs_17
    s_add_u32 m0, s3, 12288
    s_add_u32 s71, s99, s4
    buffer_load_dwordx4 v4, s[20:23], s71 offen lds
L_xs_17:
    s_add_u32 m0, s3, 0
    s_add_u32 s71, s96, s4
    buffer_load_dwordx4 v4, s[20:23], s71 offen lds
    s_lshr_b32 s73, s73, 8
    s_mul_i32 s73, s73, 5
    s_sub_u32 s67, s72, s73
    s_and_b32 s73, s18, 3
    s_lshl_b32 s72, s67, 2
    s_add_u32 s72, s72, s73
    s_mul_i32 s68, s72, 40960
    s_mul_i32 s69, s73, 5120
    s_movk_i32 s73, 6554
    s_mul_i32 s74, s66, 160
    s_movk_i32 s75, 1280
    v_add_u32 v200, 0, v0
    v_mul_u32_u24 v201, s73, v200
    v_lshrrev_b32 v201, 16, v201
    v_mul_u32_u24 v202, 10, v201
    s_mul_i32 s70, s4, 1920
    s_add_u32 m0, s5, 0
    s_nop 0
    buffer_load_dwordx4 v8, s[24:27], s70 offen lds
    s_add_u32 m0, s5, 1024
    s_nop 0
    buffer_load_dwordx4 v9, s[24:27], s70 offen lds
    s_add_u32 m0, s5, 2048
    s_nop 0
    buffer_load_dwordx4 v10, s[24:27], s70 offen lds
    s_add_u32 m0, s5, 3072
    s_mov_b64 exec, s[86:87]
    buffer_load_dwordx4 v11, s[24:27], s70 offen lds
    s_mov_b64 exec, -1
    s_add_u32 s5, s5, 15360
    s_cmp_ge_u32 s5, 76800
    s_cselect_b32 s71, 76800, 0
    s_sub_u32 s5, s5, s71
    s_waitcnt vmcnt(16)
    s_barrier
    s_add_u32 m0, s3, 4096
    s_add_u32 s71, s97, s4
    buffer_load_dwordx4 v4, s[20:23], s71 offen lds
    s_add_u32 m0, s3, 8192
    s_add_u32 s71, s98, s4
    buffer_load_dwordx4 v4, s[20:23], s71 offen lds
    s_add_u32 s3, s3, 14336
    s_cmp_ge_u32 s3, 119808
    s_cselect_b32 s71, 43008, 0
    s_sub_u32 s3, s3, s71
    v_sub_u32 v203, v200, v202
    v_lshl_add_u32 v203, v203, 4, s74
    v_bfe_u32 v202, v201, 2, 2
    v_lshl_add_u32 v202, v202, 2, v201
    v_lshrrev_b32 v204, 4, v201
    v_mul_u32_u24 v204, 12, v204
    v_sub_u32 v202, v202, v204
    v_mad_u32_u24 v238, v202, s75, v203
    v_add_u32 v200, 64, v0
    v_mul_u32_u24 v201, s73, v200
    v_lshrrev_b32 v201, 16, v201
    v_mul_u32_u24 v202, 10, v201
    v_sub_u32 v203, v200, v202
    v_lshl_add_u32 v203, v203, 4, s74
    v_bfe_u32 v202, v201, 2, 2
    s_add_u32 s70, s70, 122880
    s_add_u32 m0, s5, 0
    s_nop 0
    buffer_load_dwordx4 v8, s[24:27], s70 offen lds
    s_add_u32 m0, s5, 1024
    s_nop 0
    buffer_load_dwordx4 v9, s[24:27], s70 offen lds
    s_add_u32 m0, s5, 2048
    s_nop 0
    buffer_load_dwordx4 v10, s[24:27], s70 offen lds
    s_add_u32 m0, s5, 3072
    s_mov_b64 exec, s[86:87]
    buffer_load_dwordx4 v11, s[24:27], s70 offen lds
    s_mov_b64 exec, -1
    s_add_u32 s5, s5, 15360
    s_cmp_ge_u32 s5, 76800
    s_cselect_b32 s71, 76800, 0
    s_sub_u32 s5, s5, s71
    s_waitcnt vmcnt(15)
    s_barrier
    s_mov_b32 s4, 768
    s_cbranch_vccnz L_xs_18
    s_add_u32 m0, s3, 12288
    s_add_u32 s71, s99, s4
    buffer_load_dwordx4 v4, s[20:23], s71 offen lds
L_xs_18:
    s_add_u32 m0, s3, 0
    s_add_u32 s71, s96, s4
    buffer_load_dwordx4 v4, s[20:23], s71 offen lds
    v_lshl_add_u32 v202, v202, 2, v201
    v_lshrrev_b32 v204, 4, v201
    v_mul_u32_u24 v204, 12, v204
    v_sub_u32 v202, v202, v204
    v_mad_u32_u24 v239, v202, s75, v203
    v_add_u32 v200, 128, v0
    v_mul_u32_u24 v201, s73, v200
    v_lshrrev_b32 v201, 16, v201
    v_mul_u32_u24 v202, 10, v201
    v_sub_u32 v203, v200, v202
    v_lshl_add_u32 v203, v203, 4, s74
    v_bfe_u32 v202, v201, 2, 2
    v_lshl_add_u32 v202, v202, 2, v201
    v_lshrrev_b32 v204, 4, v201
    v_mul_u32_u24 v204, 12, v204
    s_mul_i32 s70, s4, 1920
    s_add_u32 m0, s5, 0
    s_nop 0
    buffer_load_dwordx4 v8, s[24:27], s70 offen lds
    s_add_u32 m0, s5, 1024
    s_nop 0
    buffer_load_dwordx4 v9, s[24:27], s70 offen lds
    s_add_u32 m0, s5, 2048
    s_nop 0
    buffer_load_dwordx4 v10, s[24:27], s70 offen lds
    s_add_u32 m0, s5, 3072
    s_mov_b64 exec, s[86:87]
    buffer_load_dwordx4 v11, s[24:27], s70 offen lds
    s_mov_b64 exec, -1
    s_add_u32 s5, s5, 15360
    s_cmp_ge_u32 s5, 76800
    s_cselect_b32 s71, 76800, 0
    s_sub_u32 s5, s5, s71
    s_waitcnt vmcnt(16)
    s_barrier
    s_add_u32 m0, s3, 4096
    s_add_u32 s71, s97, s4
    buffer_load_dwordx4 v4, s[20:23], s71 offen lds
    s_add_u32 m0, s3, 8192
    s_add_u32 s71, s98, s4
    buffer_load_dwordx4 v4, s[20:23], s71 offen lds
    s_add_u32 s3, s3, 14336
    s_cmp_ge_u32 s3, 119808
    s_cselect_b32 s71, 43008, 0
    s_sub_u32 s3, s3, s71
    v_sub_u32 v202, v202, v204
    v_mad_u32_u24 v240, v202, s75, v203
    v_add_u32 v200, 192, v0
    v_mul_u32_u24 v201, s73, v200
    v_lshrrev_b32 v201, 16, v201
    v_mul_u32_u24 v202, 10, v201
    v_sub_u32 v203, v200, v202
    v_lshl_add_u32 v203, v203, 4, s74
    v_bfe_u32 v202, v201, 2, 2
    v_lshl_add_u32 v202, v202, 2, v201
    v_lshrrev_b32 v204, 4, v201
    v_mul_u32_u24 v204, 12, v204
    v_sub_u32 v202, v202, v204
    v_mad_u32_u24 v241, v202, s75, v203
    v_add_u32 v200, 256, v0
    s_add_u32 s70, s70, 122880
    s_add_u32 m0, s5, 0
    s_nop 0
    buffer_load_dwordx4 v8, s[24:27], s70 offen lds
    s_add_u32 m0, s5, 1024
    s_nop 0
    buffer_load_dwordx4 v9, s[24:27], s70 offen lds
    s_add_u32 m0, s5, 2048
    s_nop 0
    buffer_load_dwordx4 v10, s[24:27], s70 offen lds
    s_add_u32 m0, s5, 3072
    s_mov_b64 exec, s[86:87]
    buffer_load_dwordx4 v11, s[24:27], s70 offen lds
    s_mov_b64 exec, -1
    s_add_u32 s5, s5, 15360
    s_cmp_ge_u32 s5, 76800
    s_cselect_b32 s71, 76800, 0
    s_sub_u32 s5, s5, s71
    s_waitcnt vmcnt(15)
    s_barrier
    s_mov_b32 s4, 896
    s_cbranch_vccnz L_xs_19
    s_add_u32 m0, s3, 12288
    s_add_u32 s71, s99, s4
    buffer_load_dwordx4 v4, s[20:23], s71 offen lds
L_xs_19:
    s_add_u32 m0, s3, 0
    s_add_u32 s71, s96, s4
    buffer_load_dwordx4 v4, s[20:23], s71 offen lds
    v_mul_u32_u24 v201, s73, v200
    v_lshrrev_b32 v201, 16, v201
    v_mul_u32_u24 v202, 10, v201
    v_sub_u32 v203, v200, v202
    v_lshl_add_u32 v203, v203, 4, s74
    v_bfe_u32 v202, v201, 2, 2
    v_lshl_add_u32 v202, v202, 2, v201
    v_lshrrev_b32 v204, 4, v201
    v_mul_u32_u24 v204, 12, v204
    v_sub_u32 v202, v202, v204
    v_mad_u32_u24 v242, v202, s75, v203
    v_and_b32 v205, 15, v0
    v_bfe_u32 v206, v0, 4, 1
    v_lshrrev_b32 v207, 5, v0
    s_and_b32 s72, s18, 1
    s_mul_i32 s70, s4, 1920
    s_add_u32 m0, s5, 0
    s_nop 0
    buffer_load_dwordx4 v8, s[24:27], s70 offen lds
    s_add_u32 m0, s5, 1024
    s_nop 0
    buffer_load_dwordx4 v9, s[24:27], s70 offen lds
    s_add_u32 m0, s5, 2048
    s_nop 0
    buffer_load_dwordx4 v10, s[24:27], s70 offen lds
    s_add_u32 m0, s5, 3072
    s_mov_b64 exec, s[86:87]
    buffer_load_dwordx4 v11, s[24:27], s70 offen lds
    s_mov_b64 exec, -1
    s_add_u32 s5, s5, 15360
    s_cmp_ge_u32 s5, 76800
    s_cselect_b32 s71, 76800, 0
    s_sub_u32 s5, s5, s71
    s_waitcnt vmcnt(16)
    s_barrier
    s_add_u32 m0, s3, 4096
    s_add_u32 s71, s97, s4
    buffer_load_dwordx4 v4, s[20:23], s71 offen lds
    s_add_u32 m0, s3, 8192
    s_add_u32 s71, s98, s4
    buffer_load_dwordx4 v4, s[20:23], s71 offen lds
    s_add_u32 s3, s3, 14336
    s_cmp_ge_u32 s3, 119808
    s_cselect_b32 s71, 43008, 0
    s_sub_u32 s3, s3, s71
    s_lshr_b32 s73, s18, 1
    s_mul_i32 s74, s73, 7808
    s_mul_i32 s75, s72, 80
    s_add_u32 s74, s74, s75
    s_add_u32 s74, s74, 61440
    v_mul_u32_u24 v200, 40, v207
    v_mul_u32_u24 v201, 27520, v206
    v_add3_u32 v200, v200, v201, s74
    v_mul_u32_u24 v201, 488, v205
    v_add_u32 v215, v200, v201
    v_and_b32 v202, 3, v0
    v_bfe_u32 v201, v0, 2, 2
    v_lshl_add_u32 v201, v202, 2, v201
    v_mul_u32_u24 v201, 488, v201
    v_add_u32 v200, v200, v201
    s_add_u32 s70, s70, 122880
    s_add_u32 m0, s5, 0
    s_nop 0
    buffer_load_dwordx4 v8, s[24:27], s70 offen lds
    s_add_u32 m0, s5, 1024
    s_nop 0
    buffer_load_dwordx4 v9, s[24:27], s70 offen lds
    s_add_u32 m0, s5, 2048
    s_nop 0
    buffer_load_dwordx4 v10, s[24:27], s70 offen lds
    s_add_u32 m0, s5, 3072
    s_mov_b64 exec, s[86:87]
    buffer_load_dwordx4 v11, s[24:27], s70 offen lds
    s_mov_b64 exec, -1
    s_add_u32 s5, s5, 15360
    s_cmp_ge_u32 s5, 76800
    s_cselect_b32 s71, 76800, 0
    s_sub_u32 s5, s5, s71
    s_waitcnt vmcnt(15)
    s_barrier
    s_mov_b32 s4, 1024
    s_cbranch_vccnz L_xs_20
    s_add_u32 m0, s3, 12288
    s_add_u32 s71, s99, s4
    buffer_load_dwordx4 v4, s[20:23], s71 offen lds
L_xs_20:
    s_add_u32 m0, s3, 0
    s_add_u32 s71, s96, s4
    buffer_load_dwordx4 v4, s[20:23], s71 offen lds
    v_add_u32 v200, 320, v200
    v_lshl_add_u32 v216, v207, 3, v200
    v_xor_b32 v203, 1, v207
    v_lshl_add_u32 v217, v203, 5, v200
    s_mul_i32 s74, s85, 3
    s_add_u32 s74, s74, s73
    s_cmp_ge_u32 s74, 64
    s_mul_i32 s74, s74, 40960
    s_cselect_b32 s74, 0x20000000, s74
    s_mul_i32 s75, s84, 2560
    s_add_u32 s74, s74, s75
    s_mul_i32 s72, s72, 1280
    s_add_u32 s74, s74, s72
    v_mul_u32_u24 v200, 20480, v206
    v_lshl_add_u32 v200, v205, 4, v200
    v_add_u32 v200, s74, v200
    v_mul_u32_u24 v201, 768, v207
    s_mul_i32 s70, s4, 1920
    s_add_u32 m0, s5, 0
    s_nop 0
    buffer_load_dwordx4 v8, s[24:27], s70 offen lds
    s_add_u32 m0, s5, 1024
    s_nop 0
    buffer_load_dwordx4 v9, s[24:27], s70 offen lds
    s_add_u32 m0, s5, 2048
    s_nop 0
    buffer_load_dwordx4 v10, s[24:27], s70 offen lds
    s_add_u32 m0, s5, 3072
    s_mov_b64 exec, s[86:87]
    buffer_load_dwordx4 v11, s[24:27], s70 offen lds
    s_mov_b64 exec, -1
    s_add_u32 s5, s5, 15360
    s_cmp_ge_u32 s5, 76800
    s_cselect_b32 s71, 76800, 0
    s_sub_u32 s5, s5, s71
    s_waitcnt vmcnt(16)
    s_barrier
    s_add_u32 m0, s3, 4096
    s_add_u32 s71, s97, s4
    buffer_load_dwordx4 v4, s[20:23], s71 offen lds
    s_add_u32 m0, s3, 8192
    s_add_u32 s71, s98, s4
    buffer_load_dwordx4 v4, s[20:23], s71 offen lds
    s_add_u32 s3, s3, 14336
    s_cmp_ge_u32 s3, 119808
    s_cselect_b32 s71, 43008, 0
    s_sub_u32 s3, s3, s71
    v_add_u32 v218, v200, v201
    v_add_u32 v200, 512, v200
    v_lshl_or_b32 v219, v207, 30, v200
    s_or_b32 s73, s73, s85
    s_cmp_eq_u32 s73, 0
    s_cselect_b32 s72, 8, 0
    v_add_u32 v201, 1, v202
    v_and_b32 v203, 12, v0
    v_sub_u32 v203, s72, v203
    v_max_i32 v201, v201, v203
    v_add_u32 v200, 8, v202
    v_sub_u32 v200, v200, v201
    v_sub_u32 v202, 1, v201
    v_cmp_le_u32 s[44:45], v202, v200
    v_sub_u32 v202, 2, v201
    v_cmp_le_u32 s[46:47], v202, v200
    s_add_u32 s70, s70, 122880
    s_add_u32 m0, s5, 0
    s_nop 0
    buffer_load_dwordx4 v8, s[24:27], s70 offen lds
    s_add_u32 m0, s5, 1024
    s_nop 0
    buffer_load_dwordx4 v9, s[24:27], s70 offen lds
    s_add_u32 m0, s5, 2048
    s_nop 0
    buffer_load_dwordx4 v10, s[24:27], s70 offen lds
    s_add_u32 m0, s5, 3072
    s_mov_b64 exec, s[86:87]
    buffer_load_dwordx4 v11, s[24:27], s70 offen lds
    s_mov_b64 exec, -1
    s_add_u32 s5, s5, 15360
    s_cmp_ge_u32 s5, 76800
    s_cselect_b32 s71, 76800, 0
    s_sub_u32 s5, s5, s71
    s_waitcnt vmcnt(15)
    s_barrier
    s_mov_b32 s4, 1152
    s_cbranch_vccnz L_xs_21
    s_add_u32 m0, s3, 12288
    s_add_u32 s71, s99, s4
    buffer_load_dwordx4 v4, s[20:23], s71 offen lds
L_xs_21:
    s_add_u32 m0, s3, 0
    s_add_u32 s71, s96, s4
    buffer_load_dwordx4 v4, s[20:23], s71 offen lds
    v_sub_u32 v202, 3, v201
    v_cmp_le_u32 s[48:49], v202, v200
    v_sub_u32 v202, 4, v201
    v_cmp_le_u32 s[50:51], v202, v200
    v_sub_u32 v202, 5, v201
    v_cmp_le_u32 s[52:53], v202, v200
    v_sub_u32 v202, 6, v201
    v_cmp_le_u32 s[54:55], v202, v200
    v_sub_u32 v202, 7, v201
    v_cmp_le_u32 s[56:57], v202, v200
    v_sub_u32 v202, 8, v201
    v_cmp_le_u32 s[58:59], v202, v200
    v_sub_u32 v202, 9, v201
    v_cmp_le_u32 s[60:61], v202, v200
    v_sub_u32 v202, 10, v201
    s_mul_i32 s70, s4, 1920
    s_add_u32 m0, s5, 0
    s_nop 0
    buffer_load_dwordx4 v8, s[24:27], s70 offen lds
    s_add_u32 m0, s5, 1024
    s_nop 0
    buffer_load_dwordx4 v9, s[24:27], s70 offen lds
    s_add_u32 m0, s5, 2048
    s_nop 0
    buffer_load_dwordx4 v10, s[24:27], s70 offen lds
    s_add_u32 m0, s5, 3072
    s_mov_b64 exec, s[86:87]
    buffer_load_dwordx4 v11, s[24:27], s70 offen lds
    s_mov_b64 exec, -1
    s_add_u32 s5, s5, 15360
    s_cmp_ge_u32 s5, 76800
    s_cselect_b32 s71, 76800, 0
    s_sub_u32 s5, s5, s71
    s_waitcnt vmcnt(16)
    s_barrier
    s_add_u32 m0, s3, 4096
    s_add_u32 s71, s97, s4
    buffer_load_dwordx4 v4, s[20:23], s71 offen lds
    s_add_u32 m0, s3, 8192
    s_add_u32 s71, s98, s4
    buffer_load_dwordx4 v4, s[20:23], s71 offen lds
    s_add_u32 s3, s3, 14336
    s_cmp_ge_u32 s3, 119808
    s_cselect_b32 s71, 43008, 0
    s_sub_u32 s3, s3, s71
    v_cmp_le_u32 s[62:63], v202, v200
    v_sub_u32 v202, 11, v201
    v_cmp_le_u32 s[64:65], v202, v200
    s_mov_b32 s88, 1046804782
    s_mov_b32 s89, 1046804782
    s_mov_b32 s90, 1051011932
    s_mov_b32 s91, 1051011932
    s_mov_b32 s92, 0xffff0000
    s_mov_b32 s93, 0xff800000
    s_add_u32 s70, s70, 122880
    s_add_u32 m0, s5, 0
    s_nop 0
    buffer_load_dwordx4 v8, s[24:27], s70 offen lds
    s_add_u32 m0, s5, 1024
    s_nop 0
    buffer_load_dwordx4 v9, s[24:27], s70 offen lds
    s_add_u32 m0, s5, 2048
    s_nop 0
    buffer_load_dwordx4 v10, s[24:27], s70 offen lds
    s_add_u32 m0, s5, 3072
    s_mov_b64 exec, s[86:87]
    buffer_load_dwordx4 v11, s[24:27], s70 offen lds
    s_mov_b64 exec, -1
    s_add_u32 s5, s5, 15360
    s_cmp_ge_u32 s5, 76800
    s_cselect_b32 s71, 76800, 0
    s_sub_u32 s5, s5, s71
    s_waitcnt vmcnt(15)
    s_barrier
    s_add_u32 s70, s68, 0
    s_cmp_ge_u32 s70, 819200
    s_cselect_b32 s71, 819200, 0
    s_sub_u32 s70, s70, s71
    s_add_u32 m0, s69, 119808
    s_nop 0
    buffer_load_dwordx4 v238, s[28:31], s70 offen lds
    s_add_u32 m0, s69, 120832
    s_nop 0
    buffer_load_dwordx4 v239, s[28:31], s70 offen lds
    s_add_u32 m0, s69, 121856
    s_nop 0
    buffer_load_dwordx4 v240, s[28:31], s70 offen lds
    s_add_u32 m0, s69, 122880
    s_nop 0
    buffer_load_dwordx4 v241, s[28:31], s70 offen lds
    s_add_u32 m0, s69, 123904
    s_nop 0
    buffer_load_dwordx4 v242, s[28:31], s70 offen lds
    s_waitcnt vmcnt(16)
    s_barrier
    s_waitcnt vmcnt(9)
    s_barrier
    s_add_u32 s70, s68, 163840
    s_cmp_ge_u32 s70, 819200
    s_cselect_b32 s71, 819200, 0
    s_sub_u32 s70, s70, s71
    s_add_u32 m0, s69, 140288
    s_nop 0
    buffer_load_dwordx4 v238, s[28:31], s70 offen lds
    s_add_u32 m0, s69, 141312
    s_nop 0
    buffer_load_dwordx4 v239, s[28:31], s70 offen lds
    s_add_u32 m0, s69, 142336
    s_nop 0
    buffer_load_dwordx4 v240, s[28:31], s70 offen lds
    s_add_u32 m0, s69, 143360
    s_nop 0
    buffer_load_dwordx4 v241, s[28:31], s70 offen lds
    s_add_u32 m0, s69, 144384
    s_nop 0
    buffer_load_dwordx4 v242, s[28:31], s70 offen lds
    s_waitcnt vmcnt(10)
    s_barrier
    s_barrier
    s_cmp_ge_u32 s18, 6
    s_cbranch_scc1 L_a_idle
    s_barrier
    s_branch L_att
L_a_idle:
    s_add_u32 s70, s68, 327680
    s_cmp_ge_u32 s70, 819200
    s_cselect_b32 s71, 819200, 0
    s_sub_u32 s70, s70, s71
    s_add_u32 m0, s69, 0
    s_nop 0
    buffer_load_dwordx4 v238, s[28:31], s70 offen lds
    s_add_u32 m0, s69, 1024
    s_nop 0
    buffer_load_dwordx4 v239, s[28:31], s70 offen lds
    s_add_u32 m0, s69, 2048
    s_nop 0
    buffer_load_dwordx4 v240, s[28:31], s70 offen lds
    s_add_u32 m0, s69, 3072
    s_nop 0
    buffer_load_dwordx4 v241, s[28:31], s70 offen lds
    s_add_u32 m0, s69, 4096
    s_nop 0
    buffer_load_dwordx4 v242, s[28:31], s70 offen lds
    s_sub_u32 s70, s70, 81920
    s_add_u32 m0, s69, -10240
    s_nop 0
    buffer_load_dwordx4 v238, s[28:31], s70 offen lds
    s_add_u32 m0, s69, -9216
    s_nop 0
    buffer_load_dwordx4 v239, s[28:31], s70 offen lds
    s_add_u32 m0, s69, -8192
    s_nop 0
    buffer_load_dwordx4 v240, s[28:31], s70 offen lds
    s_add_u32 m0, s69, -7168
    s_nop 0
    buffer_load_dwordx4 v241, s[28:31], s70 offen lds
    s_add_u32 m0, s69, -6144
    s_nop 0
    buffer_load_dwordx4 v242, s[28:31], s70 offen lds
    s_barrier
    s_add_u32 s70, s68, 491520
    s_cmp_ge_u32 s70, 819200
    s_cselect_b32 s71, 819200, 0
    s_sub_u32 s70, s70, s71
    s_add_u32 m0, s69, 20480
    s_nop 0
    buffer_load_dwordx4 v238, s[28:31], s70 offen lds
    s_add_u32 m0, s69, 21504
    s_nop 0
    buffer_load_dwordx4 v239, s[28:31], s70 offen lds
    s_add_u32 m0, s69, 22528
    s_nop 0
    buffer_load_dwordx4 v240, s[28:31], s70 offen lds
    s_add_u32 m0, s69, 23552
    s_nop 0
    buffer_load_dwordx4 v241, s[28:31], s70 offen lds
    s_add_u32 m0, s69, 24576
    s_nop 0
    buffer_load_dwordx4 v242, s[28:31], s70 offen lds
    s_sub_u32 s70, s70, 81920
    s_add_u32 m0, s69, 10240
    s_nop 0
    buffer_load_dwordx4 v238, s[28:31], s70 offen lds
    s_add_u32 m0, s69, 11264
    s_nop 0
    buffer_load_dwordx4 v239, s[28:31], s70 offen lds
    s_add_u32 m0, s69, 12288
    s_nop 0
    buffer_load_dwordx4 v240, s[28:31], s70 offen lds
    s_add_u32 m0, s69, 13312
    s_nop 0
    buffer_load_dwordx4 v241, s[28:31], s70 offen lds
    s_add_u32 m0, s69, 14336
    s_nop 0
    buffer_load_dwordx4 v242, s[28:31], s70 offen lds
    s_add_u32 s70, s68, 655360
    s_cmp_ge_u32 s70, 819200
    s_cselect_b32 s71, 819200, 0
    s_sub_u32 s70, s70, s71
    s_add_u32 m0, s69, 40960
    s_nop 0
    buffer_load_dwordx4 v238, s[28:31], s70 offen lds
    s_add_u32 m0, s69, 41984
    s_nop 0
    buffer_load_dwordx4 v239, s[28:31], s70 offen lds
    s_add_u32 m0, s69, 43008
    s_nop 0
    buffer_load_dwordx4 v240, s[28:31], s70 offen lds
    s_add_u32 m0, s69, 44032
    s_nop 0
    buffer_load_dwordx4 v241, s[28:31], s70 offen lds
    s_add_u32 m0, s69, 45056
    s_nop 0
    buffer_load_dwordx4 v242, s[28:31], s70 offen lds
    s_sub_u32 s70, s70, 81920
    s_add_u32 m0, s69, 30720
    s_nop 0
    buffer_load_dwordx4 v238, s[28:31], s70 offen lds
    s_add_u32 m0, s69, 31744
    s_nop 0
    buffer_load_dwordx4 v239, s[28:31], s70 offen lds
    s_add_u32 m0, s69, 32768
    s_nop 0
    buffer_load_dwordx4 v240, s[28:31], s70 offen lds
    s_add_u32 m0, s69, 33792
    s_nop 0
    buffer_load_dwordx4 v241, s[28:31], s70 offen lds
    s_add_u32 m0, s69, 34816
    s_nop 0
    buffer_load_dwordx4 v242, s[28:31], s70 offen lds
    s_waitcnt vmcnt(0)
    s_barrier
    s_barrier
    s_endpgm
L_comp:
    v_mov_b32 v248, 0
    v_mov_b32 v254, 0
    v_bfrev_b32 v227, 1
    v_bfrev_b32 v228, 1
    v_bfrev_b32 v229, 1
    v_and_b32 v205, 15, v0
    v_lshrrev_b32 v206, 4, v0
    v_lshrrev_b32 v200, 1, v205
    v_xor_b32 v200, v200, v206
    v_lshlrev_b32 v200, 4, v200
    v_lshl_add_u32 v200, v205, 7, v200
    v_add_u32 v208, 76800, v200
    v_xor_b32 v209, 64, v208
    v_lshrrev_b32 v200, 2, v0
    v_and_b32 v201, 3, v0
    v_lshlrev_b32 v201, 3, v201
    v_mul_u32_u24 v202, 480, v200
    v_add_u32 v202, v202, v201
    s_add_u32 s72, s18, 1
    s_and_b32 s72, s72, 3
    s_mul_i32 s72, s72, 96
    s_add_u32 s72, s72, 96
    s_lshl_b32 s73, s18, 5
    s_cmp_eq_u32 s18, 3
    s_cselect_b32 s73, 0, s73
    v_add_u32 v210, s72, v202
    v_add_u32 v211, s73, v202
    v_lshlrev_b32 v200, 3, v206
    v_mul_u32_u24 v201, 488, v205
    v_add_u32 v201, v201, v200
    v_add_u32 v201, 61440, v201
    v_add_u32 v202, 3904, v201
    v_add_u32 v213, s72, v202
    v_add_u32 v214, s73, v202
    v_bfe_u32 v202, v0, 3, 1
    v_mul_u32_u24 v202, 23616, v202
    v_add3_u32 v212, v201, v202, s72
    s_waitcnt lgkmcnt(0)
    s_mov_b32 s32, s16
    s_and_b32 s33, s17, 0xffff
    s_mov_b32 s34, 8388608
    s_mov_b32 s35, 0x20000
    s_mov_b32 s40, s14
    s_and_b32 s41, s15, 0xffff
    s_mov_b32 s42, 256
    s_mov_b32 s43, 0x20000
    s_mov_b32 s36, s12
    s_and_b32 s37, s13, 0xffff
    s_mov_b32 s38, 5242880
    s_mov_b32 s39, 0x20000
    s_and_b32 s66, s19, 7
    s_and_b32 s72, s2, 7
    s_lshl_b32 s72, s72, 2
    s_lshr_b32 s73, s19, 3
    s_add_u32 s72, s72, s73
    s_add_u32 s72, s72, s66
    s_mul_i32 s73, s72, 52
    s_lshr_b32 s73, s73, 8
    s_mul_i32 s73, s73, 5
    s_sub_u32 s67, s72, s73
    s_and_b32 s72, s2, 7
    s_lshl_b32 s72, s72, 2
    s_lshr_b32 s73, s19, 3
    s_add_u32 s72, s72, s73
    s_lshl_b32 s74, s72, 2
    s_add_u32 s74, s74, s18
    s_mul_i32 s73, s74, 43
    s_lshr_b32 s73, s73, 8
    s_lshl_b32 s73, s73, 10
    s_add_u32 s83, s73, 6815744
    s_mul_i32 s73, s74, 20480
    s_add_u32 s75, s67, 0
    s_cmp_ge_u32 s75, 5
    s_cselect_b32 s71, 5, 0
    s_sub_u32 s75, s75, s71
    s_lshl_b32 s75, s75, 12
    s_add_u32 s78, s75, s73
    s_add_u32 s75, s67, 1
    s_cmp_ge_u32 s75, 5
    s_cselect_b32 s71, 5, 0
    s_sub_u32 s75, s75, s71
    s_lshl_b32 s75, s75, 12
    s_add_u32 s79, s75, s73
    s_add_u32 s75, s67, 2
    s_cmp_ge_u32 s75, 5
    s_cselect_b32 s71, 5, 0
    s_sub_u32 s75, s75, s71
    s_lshl_b32 s75, s75, 12
    s_add_u32 s80, s75, s73
    s_add_u32 s75, s67, 3
    s_cmp_ge_u32 s75, 5
    s_cselect_b32 s71, 5, 0
    s_sub_u32 s75, s75, s71
    s_lshl_b32 s75, s75, 12
    s_add_u32 s81, s75, s73
    s_add_u32 s75, s67, 4
    s_cmp_ge_u32 s75, 5
    s_cselect_b32 s71, 5, 0
    s_sub_u32 s75, s75, s71
    s_lshl_b32 s75, s75, 12
    s_add_u32 s82, s75, s73
    s_lshr_b32 s72, s74, 1
    s_lshl_b32 s72, s72, 5
    s_and_b32 s73, s74, 1
    s_add_u32 s72, s72, s73
    s_mul_i32 s72, s72, 2560
    s_mul_i32 s73, s66, 160
    s_add_u32 s72, s72, s73
    s_mul_i32 s73, s18, 2816
    s_add_u32 s73, s73, 107520
    s_movk_i32 s75, 6554
    v_add_u32 v200, 0, v0
    v_mul_u32_u24 v201, s75, v200
    v_lshrrev_b32 v201, 16, v201
    v_mul_u32_u24 v202, 10, v201
    v_sub_u32 v200, v200, v202
    v_lshlrev_b32 v200, 4, v200
    v_mul_u32_u24 v202, 176, v201
    v_add3_u32 v224, v202, v200, s73
    v_mul_u32_u24 v202, 5120, v201
    v_add3_u32 v227, v202, v200, s72
    v_add_u32 v200, 64, v0
    v_mul_u32_u24 v201, s75, v200
    v_lshrrev_b32 v201, 16, v201
    v_mul_u32_u24 v202, 10, v201
    v_sub_u32 v200, v200, v202
    v_lshlrev_b32 v200, 4, v200
    v_mul_u32_u24 v202, 176, v201
    v_add3_u32 v225, v202, v200, s73
    v_mul_u32_u24 v202, 5120, v201
    v_add3_u32 v228, v202, v200, s72
    v_add_u32 v200, 128, v0
    v_mul_u32_u24 v201, s75, v200
    v_lshrrev_b32 v201, 16, v201
    v_mul_u32_u24 v202, 10, v201
    v_sub_u32 v200, v200, v202
    v_lshlrev_b32 v200, 4, v200
    v_mul_u32_u24 v202, 176, v201
    v_add3_u32 v226, v202, v200, s73
    v_mul_u32_u24 v202, 5120, v201
    v_add3_u32 v229, v202, v200, s72
    v_lshrrev_b32 v200, 5, v0
    v_lshl_or_b32 v229, v200, 30, v229
    v_mul_u32_u24 v200, 704, v200
    v_sub_u32 v226, v226, v200
    v_and_b32 v200, 15, v0
    v_mul_u32_u24 v200, 176, v200
    v_lshrrev_b32 v201, 4, v0
    v_lshl_add_u32 v200, v201, 3, v200
    v_add_u32 v253, s73, v200
    v_lshlrev_b32 v254, 7, v0
    v_lshrrev_b32 v200, 2, v0
    v_mul_u32_u24 v200, 160, v200
    v_and_b32 v201, 3, v0
    v_lshl_add_u32 v251, v201, 3, v200
    v_add_u32 v252, 119808, v251
    v_and_b32 v205, 15, v0
    v_bfe_u32 v206, v0, 4, 1
    v_lshrrev_b32 v207, 5, v0
    s_and_b32 s72, s18, 1
    s_lshr_b32 s73, s18, 1
    s_mul_i32 s74, s73, 7808
    s_mul_i32 s75, s72, 80
    s_add_u32 s74, s74, s75
    s_add_u32 s74, s74, 61440
    v_mul_u32_u24 v200, 40, v207
    v_mul_u32_u24 v201, 27520, v206
    v_add3_u32 v200, v200, v201, s74
    v_mul_u32_u24 v201, 488, v205
    v_add_u32 v215, v200, v201
    v_and_b32 v202, 3, v0
    v_bfe_u32 v201, v0, 2, 2
    v_lshl_add_u32 v201, v202, 2, v201
    v_mul_u32_u24 v201, 488, v201
    v_add_u32 v200, v200, v201
    v_add_u32 v200, 320, v200
    v_lshl_add_u32 v216, v207, 3, v200
    v_xor_b32 v203, 1, v207
    v_lshl_add_u32 v217, v203, 5, v200
    s_mul_i32 s74, s85, 3
    s_add_u32 s74, s74, s73
    s_cmp_ge_u32 s74, 64
    s_mul_i32 s74, s74, 40960
    s_cselect_b32 s74, 0x20000000, s74
    s_mul_i32 s75, s84, 2560
    s_add_u32 s74, s74, s75
    s_mul_i32 s72, s72, 1280
    s_add_u32 s74, s74, s72
    v_mul_u32_u24 v200, 20480, v206
    v_lshl_add_u32 v200, v205, 4, v200
    v_add_u32 v200, s74, v200
    v_mul_u32_u24 v201, 768, v207
    v_add_u32 v218, v200, v201
    v_add_u32 v200, 512, v200
    v_lshl_or_b32 v219, v207, 30, v200
    s_or_b32 s73, s73, s85
    s_cmp_eq_u32 s73, 0
    s_cselect_b32 s72, 8, 0
    v_add_u32 v201, 1, v202
    v_and_b32 v203, 12, v0
    v_sub_u32 v203, s72, v203
    v_max_i32 v201, v201, v203
    v_add_u32 v200, 8, v202
    v_sub_u32 v200, v200, v201
    v_sub_u32 v202, 1, v201
    v_cmp_le_u32 s[44:45], v202, v200
    v_sub_u32 v202, 2, v201
    v_cmp_le_u32 s[46:47], v202, v200
    v_sub_u32 v202, 3, v201
    v_cmp_le_u32 s[48:49], v202, v200
    v_sub_u32 v202, 4, v201
    v_cmp_le_u32 s[50:51], v202, v200
    v_sub_u32 v202, 5, v201
    v_cmp_le_u32 s[52:53], v202, v200
    v_sub_u32 v202, 6, v201
    v_cmp_le_u32 s[54:55], v202, v200
    v_sub_u32 v202, 7, v201
    v_cmp_le_u32 s[56:57], v202, v200
    v_sub_u32 v202, 8, v201
    v_cmp_le_u32 s[58:59], v202, v200
    v_sub_u32 v202, 9, v201
    v_cmp_le_u32 s[60:61], v202, v200
    v_sub_u32 v202, 10, v201
    v_cmp_le_u32 s[62:63], v202, v200
    v_sub_u32 v202, 11, v201
    v_cmp_le_u32 s[64:65], v202, v200
    s_mov_b32 s88, 1046804782
    s_mov_b32 s89, 1046804782
    s_mov_b32 s90, 1051011932
    s_mov_b32 s91, 1051011932
    s_mov_b32 s92, 0xffff0000
    s_mov_b32 s93, 0xff800000
    s_cmp_eq_u32 s18, 3
    s_cselect_b64 vcc, -1, 0
    s_mov_b32 s94, 0
    s_mov_b32 s95, 0
    s_mov_b32 s96, 9
    v_mov_b32 v220, v210
    v_mov_b32 v221, v211
    v_mov_b32 v222, v208
    v_mov_b32 v4, 0
    v_mov_b32 v5, 0
    v_mov_b32 v6, 0
    v_mov_b32 v7, 0
    v_mov_b32 v8, 0
    v_mov_b32 v9, 0
    v_mov_b32 v10, 0
    v_mov_b32 v11, 0
    v_mov_b32 v12, 0
    v_mov_b32 v13, 0
    v_mov_b32 v14, 0
    v_mov_b32 v15, 0
    v_mov_b32 v16, 0
    v_mov_b32 v17, 0
    v_mov_b32 v18, 0
    v_mov_b32 v19, 0
    v_mov_b32 v20, 0
    v_mov_b32 v21, 0
    v_mov_b32 v22, 0
    v_mov_b32 v23, 0
    v_mov_b32 v24, 0
    v_mov_b32 v25, 0
    v_mov_b32 v26, 0
    v_mov_b32 v27, 0
    v_mov_b32 v28, 0
    v_mov_b32 v29, 0
    v_mov_b32 v30, 0
    v_mov_b32 v31, 0
    v_mov_b32 v32, 0
    v_mov_b32 v33, 0
    v_mov_b32 v34, 0
    v_mov_b32 v35, 0
    v_mov_b32 v36, 0
    v_mov_b32 v37, 0
    v_mov_b32 v38, 0
    v_mov_b32 v39, 0
    v_mov_b32 v40, 0
    v_mov_b32 v41, 0
    v_mov_b32 v42, 0
    v_mov_b32 v43, 0
    v_mov_b32 v44, 0
    v_mov_b32 v45, 0
    v_mov_b32 v46, 0
    v_mov_b32 v47, 0
    v_mov_b32 v48, 0
    v_mov_b32 v49, 0
    v_mov_b32 v50, 0
    v_mov_b32 v51, 0
    v_mov_b32 v52, 0
    v_mov_b32 v53, 0
    v_mov_b32 v54, 0
    v_mov_b32 v55, 0
    v_mov_b32 v56, 0
    v_mov_b32 v57, 0
    v_mov_b32 v58, 0
    v_mov_b32 v59, 0
    v_mov_b32 v60, 0
    v_mov_b32 v61, 0
    v_mov_b32 v62, 0
    v_mov_b32 v63, 0
    v_mov_b32 v64, 0
    v_mov_b32 v65, 0
    v_mov_b32 v66, 0
    v_mov_b32 v67, 0
    v_mov_b32 v68, 0
    v_mov_b32 v69, 0
    v_mov_b32 v70, 0
    v_mov_b32 v71, 0
    v_mov_b32 v72, 0
    v_mov_b32 v73, 0
    v_mov_b32 v74, 0
    v_mov_b32 v75, 0
    v_mov_b32 v76, 0
    v_mov_b32 v77, 0
    v_mov_b32 v78, 0
    v_mov_b32 v79, 0
    v_mov_b32 v80, 0
    v_mov_b32 v81, 0
    v_mov_b32 v82, 0
    v_mov_b32 v83, 0
    v_mov_b32 v84, 0
    v_mov_b32 v85, 0
    v_mov_b32 v86, 0
    v_mov_b32 v87, 0
    v_mov_b32 v88, 0
    v_mov_b32 v89, 0
    v_mov_b32 v90, 0
    v_mov_b32 v91, 0
    v_mov_b32 v92, 0
    v_mov_b32 v93, 0
    v_mov_b32 v94, 0
    v_mov_b32 v95, 0
    v_mov_b32 v96, 0
    v_mov_b32 v97, 0
    v_mov_b32 v98, 0
    v_mov_b32 v99, 0
    v_mov_b32 v100, 0
    v_mov_b32 v101, 0
    v_mov_b32 v102, 0
    v_mov_b32 v103, 0
    s_barrier
    ds_read_b64_tr_b16 v[132:133], v220 offset:0
    ds_read_b64_tr_b16 v[134:135], v220 offset:7680
    ds_read_b128 v[108:111], v222 offset:2048
    ds_read_b64_tr_b16 v[136:137], v220 offset:32
    ds_read_b64_tr_b16 v[138:139], v220 offset:7712
    ds_read_b128 v[112:115], v222 offset:4096
    ds_read_b64_tr_b16 v[140:141], v220 offset:64
    ds_read_b64_tr_b16 v[142:143], v220 offset:7744
    ds_read_b128 v[116:119], v222 offset:6144
    ds_read_b128 v[120:123], v222 offset:8192
    ds_read_b128 v[124:127], v222 offset:10240
    ds_read_b128 v[128:131], v222 offset:12288
    ds_read_b128 v[104:107], v222 offset:0
    ds_read_b64_tr_b16 v[144:145], v221 offset:0
    ds_read_b64_tr_b16 v[146:147], v221 offset:7680
    ds_read_b64_tr_b16 v[148:149], v221 offset:32
    ds_read_b64_tr_b16 v[150:151], v221 offset:7712
    ds_read_b64_tr_b16 v[152:153], v221 offset:64
    ds_read_b64_tr_b16 v[154:155], v221 offset:7744
    s_add_u32 s94, s94, 15360
    s_cmp_eq_u32 s94, 76800
    s_cselect_b32 s94, 0, s94
    v_add_u32 v220, s94, v210
    v_add_u32 v221, s94, v211
    v_add_u32 v222, s95, v209
    s_waitcnt lgkmcnt(0)
    s_barrier
.p2align 6
L_gemm:
    s_cbranch_vccnz L_w3_1
    v_mfma_f32_16x16x32_bf16 v[88:91], v[144:147], v[108:111], v[88:91]
    ds_read_b64_tr_b16 v[196:197], v221 offset:0
    v_mfma_f32_16x16x32_bf16 v[92:95], v[144:147], v[112:115], v[92:95]
    ds_read_b64_tr_b16 v[198:199], v221 offset:7680
    v_mfma_f32_16x16x32_bf16 v[96:99], v[144:147], v[116:119], v[96:99]
    v_mfma_f32_16x16x32_bf16 v[100:103], v[144:147], v[120:123], v[100:103]
    v_mfma_f32_16x16x32_bf16 v[4:7], v[132:135], v[104:107], v[4:7]
    v_mfma_f32_16x16x32_bf16 v[32:35], v[136:139], v[104:107], v[32:35]
    s_branch L_wj_2
L_w3_1:
    v_mfma_f32_16x16x32_bf16 v[88:91], v[144:147], v[124:127], v[88:91]
    ds_read_b64_tr_b16 v[196:197], v221 offset:0
    v_mfma_f32_16x16x32_bf16 v[92:95], v[144:147], v[128:131], v[92:95]
    ds_read_b64_tr_b16 v[198:199], v221 offset:7680
    v_mfma_f32_16x16x32_bf16 v[96:99], v[148:151], v[124:127], v[96:99]
    ds_read_b64_tr_b16 v[200:201], v221 offset:32
    v_mfma_f32_16x16x32_bf16 v[100:103], v[148:151], v[128:131], v[100:103]
    ds_read_b64_tr_b16 v[202:203], v221 offset:7712
    v_mfma_f32_16x16x32_bf16 v[4:7], v[152:155], v[124:127], v[4:7]
    ds_read_b64_tr_b16 v[204:205], v221 offset:64
    v_mfma_f32_16x16x32_bf16 v[32:35], v[152:155], v[128:131], v[32:35]
    ds_read_b64_tr_b16 v[206:207], v221 offset:7744
L_wj_2:
    v_mfma_f32_16x16x32_bf16 v[8:11], v[132:135], v[108:111], v[8:11]
    ds_read_b64_tr_b16 v[184:185], v220 offset:0
    v_mfma_f32_16x16x32_bf16 v[36:39], v[136:139], v[108:111], v[36:39]
    ds_read_b64_tr_b16 v[186:187], v220 offset:7680
    v_mfma_f32_16x16x32_bf16 v[64:67], v[140:143], v[108:111], v[64:67]
    ds_read_b128 v[160:163], v222 offset:2048
    v_mfma_f32_16x16x32_bf16 v[12:15], v[132:135], v[112:115], v[12:15]
    ds_read_b64_tr_b16 v[188:189], v220 offset:32
    v_mfma_f32_16x16x32_bf16 v[40:43], v[136:139], v[112:115], v[40:43]
    ds_read_b64_tr_b16 v[190:191], v220 offset:7712
    v_mfma_f32_16x16x32_bf16 v[68:71], v[140:143], v[112:115], v[68:71]
    ds_read_b128 v[164:167], v222 offset:4096
    v_mfma_f32_16x16x32_bf16 v[16:19], v[132:135], v[116:119], v[16:19]
    ds_read_b64_tr_b16 v[192:193], v220 offset:64
    v_mfma_f32_16x16x32_bf16 v[44:47], v[136:139], v[116:119], v[44:47]
    ds_read_b64_tr_b16 v[194:195], v220 offset:7744
    v_mfma_f32_16x16x32_bf16 v[72:75], v[140:143], v[116:119], v[72:75]
    ds_read_b128 v[168:171], v222 offset:6144
    v_mfma_f32_16x16x32_bf16 v[20:23], v[132:135], v[120:123], v[20:23]
    ds_read_b128 v[172:175], v222 offset:8192
    v_mfma_f32_16x16x32_bf16 v[48:51], v[136:139], v[120:123], v[48:51]
    ds_read_b128 v[176:179], v222 offset:10240
    v_mfma_f32_16x16x32_bf16 v[76:79], v[140:143], v[120:123], v[76:79]
    ds_read_b128 v[180:183], v222 offset:12288
    v_mfma_f32_16x16x32_bf16 v[24:27], v[132:135], v[124:127], v[24:27]
    ds_read_b128 v[156:159], v222 offset:0
    v_mfma_f32_16x16x32_bf16 v[52:55], v[136:139], v[124:127], v[52:55]
    s_add_u32 s94, s94, 15360
    s_cmp_eq_u32 s94, 76800
    s_cselect_b32 s94, 0, s94
    v_mfma_f32_16x16x32_bf16 v[80:83], v[140:143], v[124:127], v[80:83]
    s_add_u32 s95, s95, 14336
    s_cmp_eq_u32 s95, 43008
    s_cselect_b32 s95, 0, s95
    v_mfma_f32_16x16x32_bf16 v[28:31], v[132:135], v[128:131], v[28:31]
    v_add_u32 v220, s94, v210
    v_mfma_f32_16x16x32_bf16 v[56:59], v[136:139], v[128:131], v[56:59]
    v_add_u32 v221, s94, v211
    v_mfma_f32_16x16x32_bf16 v[84:87], v[140:143], v[128:131], v[84:87]
    v_add_u32 v222, s95, v208
    v_mfma_f32_16x16x32_bf16 v[60:63], v[140:143], v[104:107], v[60:63]
    s_waitcnt lgkmcnt(0)
    s_barrier
    s_cbranch_vccnz L_w3_3
    v_mfma_f32_16x16x32_bf16 v[88:91], v[196:199], v[160:163], v[88:91]
    ds_read_b64_tr_b16 v[144:145], v221 offset:0
    v_mfma_f32_16x16x32_bf16 v[92:95], v[196:199], v[164:167], v[92:95]
    ds_read_b64_tr_b16 v[146:147], v221 offset:7680
    v_mfma_f32_16x16x32_bf16 v[96:99], v[196:199], v[168:171], v[96:99]
    v_mfma_f32_16x16x32_bf16 v[100:103], v[196:199], v[172:175], v[100:103]
    v_mfma_f32_16x16x32_bf16 v[4:7], v[184:187], v[156:159], v[4:7]
    v_mfma_f32_16x16x32_bf16 v[32:35], v[188:191], v[156:159], v[32:35]
    s_branch L_wj_4
L_w3_3:
    v_mfma_f32_16x16x32_bf16 v[88:91], v[196:199], v[176:179], v[88:91]
    ds_read_b64_tr_b16 v[144:145], v221 offset:0
    v_mfma_f32_16x16x32_bf16 v[92:95], v[196:199], v[180:183], v[92:95]
    ds_read_b64_tr_b16 v[146:147], v221 offset:7680
    v_mfma_f32_16x16x32_bf16 v[96:99], v[200:203], v[176:179], v[96:99]
    ds_read_b64_tr_b16 v[148:149], v221 offset:32
    v_mfma_f32_16x16x32_bf16 v[100:103], v[200:203], v[180:183], v[100:103]
    ds_read_b64_tr_b16 v[150:151], v221 offset:7712
    v_mfma_f32_16x16x32_bf16 v[4:7], v[204:207], v[176:179], v[4:7]
    ds_read_b64_tr_b16 v[152:153], v221 offset:64
    v_mfma_f32_16x16x32_bf16 v[32:35], v[204:207], v[180:183], v[32:35]
    ds_read_b64_tr_b16 v[154:155], v221 offset:7744
L_wj_4:
    v_mfma_f32_16x16x32_bf16 v[8:11], v[184:187], v[160:163], v[8:11]
    ds_read_b64_tr_b16 v[132:133], v220 offset:0
    v_mfma_f32_16x16x32_bf16 v[36:39], v[188:191], v[160:163], v[36:39]
    ds_read_b64_tr_b16 v[134:135], v220 offset:7680
    v_mfma_f32_16x16x32_bf16 v[64:67], v[192:195], v[160:163], v[64:67]
    ds_read_b128 v[108:111], v222 offset:2048
    v_mfma_f32_16x16x32_bf16 v[12:15], v[184:187], v[164:167], v[12:15]
    ds_read_b64_tr_b16 v[136:137], v220 offset:32
    v_mfma_f32_16x16x32_bf16 v[40:43], v[188:191], v[164:167], v[40:43]
    ds_read_b64_tr_b16 v[138:139], v220 offset:7712
    v_mfma_f32_16x16x32_bf16 v[68:71], v[192:195], v[164:167], v[68:71]
    ds_read_b128 v[112:115], v222 offset:4096
    v_mfma_f32_16x16x32_bf16 v[16:19], v[184:187], v[168:171], v[16:19]
    ds_read_b64_tr_b16 v[140:141], v220 offset:64
    v_mfma_f32_16x16x32_bf16 v[44:47], v[188:191], v[168:171], v[44:47]
    ds_read_b64_tr_b16 v[142:143], v220 offset:7744
    v_mfma_f32_16x16x32_bf16 v[72:75], v[192:195], v[168:171], v[72:75]
    ds_read_b128 v[116:119], v222 offset:6144
    v_mfma_f32_16x16x32_bf16 v[20:23], v[184:187], v[172:175], v[20:23]
    ds_read_b128 v[120:123], v222 offset:8192
    v_mfma_f32_16x16x32_bf16 v[48:51], v[188:191], v[172:175], v[48:51]
    ds_read_b128 v[124:127], v222 offset:10240
    v_mfma_f32_16x16x32_bf16 v[76:79], v[192:195], v[172:175], v[76:79]
    ds_read_b128 v[128:131], v222 offset:12288
    v_mfma_f32_16x16x32_bf16 v[24:27], v[184:187], v[176:179], v[24:27]
    ds_read_b128 v[104:107], v222 offset:0
    v_mfma_f32_16x16x32_bf16 v[52:55], v[188:191], v[176:179], v[52:55]
    s_add_u32 s94, s94, 15360
    s_cmp_eq_u32 s94, 76800
    s_cselect_b32 s94, 0, s94
    v_mfma_f32_16x16x32_bf16 v[80:83], v[192:195], v[176:179], v[80:83]
    s_sub_u32 s96, s96, 1
    v_mfma_f32_16x16x32_bf16 v[28:31], v[184:187], v[180:183], v[28:31]
    v_add_u32 v220, s94, v210
    v_mfma_f32_16x16x32_bf16 v[56:59], v[188:191], v[180:183], v[56:59]
    v_add_u32 v221, s94, v211
    v_mfma_f32_16x16x32_bf16 v[84:87], v[192:195], v[180:183], v[84:87]
    v_add_u32 v222, s95, v209
    v_mfma_f32_16x16x32_bf16 v[60:63], v[192:195], v[156:159], v[60:63]
    s_waitcnt lgkmcnt(0)
    s_cmp_lg_u32 s96, 0
    s_barrier
    s_cbranch_scc1 L_gemm
    s_cbranch_vccnz L_w3_5
    v_mfma_f32_16x16x32_bf16 v[88:91], v[144:147], v[108:111], v[88:91]
    ds_read_b64_tr_b16 v[196:197], v221 offset:0
    ds_read_b64_tr_b16 v[198:199], v221 offset:7680
    ds_read_b64_tr_b16 v[184:185], v220 offset:0
    v_mfma_f32_16x16x32_bf16 v[92:95], v[144:147], v[112:115], v[92:95]
    ds_read_b64_tr_b16 v[186:187], v220 offset:7680
    ds_read_b128 v[160:163], v222 offset:2048
    ds_read_b64_tr_b16 v[188:189], v220 offset:32
    v_mfma_f32_16x16x32_bf16 v[96:99], v[144:147], v[116:119], v[96:99]
    ds_read_b64_tr_b16 v[190:191], v220 offset:7712
    ds_read_b128 v[164:167], v222 offset:4096
    ds_read_b64_tr_b16 v[192:193], v220 offset:64
    v_mfma_f32_16x16x32_bf16 v[100:103], v[144:147], v[120:123], v[100:103]
    ds_read_b64_tr_b16 v[194:195], v220 offset:7744
    ds_read_b128 v[168:171], v222 offset:6144
    ds_read_b128 v[172:175], v222 offset:8192
    v_mfma_f32_16x16x32_bf16 v[4:7], v[132:135], v[104:107], v[4:7]
    ds_read_b128 v[176:179], v222 offset:10240
    ds_read_b128 v[180:183], v222 offset:12288
    ds_read_b128 v[156:159], v222 offset:0
    v_mfma_f32_16x16x32_bf16 v[32:35], v[136:139], v[104:107], v[32:35]
    s_branch L_wj_6
L_w3_5:
    v_mfma_f32_16x16x32_bf16 v[88:91], v[144:147], v[124:127], v[88:91]
    ds_read_b64_tr_b16 v[196:197], v221 offset:0
    ds_read_b64_tr_b16 v[198:199], v221 offset:7680
    ds_read_b64_tr_b16 v[200:201], v221 offset:32
    ds_read_b64_tr_b16 v[202:203], v221 offset:7712
    v_mfma_f32_16x16x32_bf16 v[92:95], v[144:147], v[128:131], v[92:95]
    ds_read_b64_tr_b16 v[204:205], v221 offset:64
    ds_read_b64_tr_b16 v[206:207], v221 offset:7744
    ds_read_b64_tr_b16 v[184:185], v220 offset:0
    ds_read_b64_tr_b16 v[186:187], v220 offset:7680
    v_mfma_f32_16x16x32_bf16 v[96:99], v[148:151], v[124:127], v[96:99]
    ds_read_b128 v[160:163], v222 offset:2048
    ds_read_b64_tr_b16 v[188:189], v220 offset:32
    ds_read_b64_tr_b16 v[190:191], v220 offset:7712
    ds_read_b128 v[164:167], v222 offset:4096
    v_mfma_f32_16x16x32_bf16 v[100:103], v[148:151], v[128:131], v[100:103]
    ds_read_b64_tr_b16 v[192:193], v220 offset:64
    ds_read_b64_tr_b16 v[194:195], v220 offset:7744
    ds_read_b128 v[168:171], v222 offset:6144
    ds_read_b128 v[172:175], v222 offset:8192
    v_mfma_f32_16x16x32_bf16 v[4:7], v[152:155], v[124:127], v[4:7]
    ds_read_b128 v[176:179], v222 offset:10240
    ds_read_b128 v[180:183], v222 offset:12288
    ds_read_b128 v[156:159], v222 offset:0
    v_mfma_f32_16x16x32_bf16 v[32:35], v[152:155], v[128:131], v[32:35]
L_wj_6:
    v_mfma_f32_16x16x32_bf16 v[8:11], v[132:135], v[108:111], v[8:11]
    v_mfma_f32_16x16x32_bf16 v[36:39], v[136:139], v[108:111], v[36:39]
    v_mfma_f32_16x16x32_bf16 v[64:67], v[140:143], v[108:111], v[64:67]
    v_mfma_f32_16x16x32_bf16 v[12:15], v[132:135], v[112:115], v[12:15]
    s_waitcnt lgkmcnt(0)
    s_barrier
    s_cbranch_vccnz L_w3_7
    v_mfma_f32_16x16x32_bf16 v[88:91], v[196:199], v[160:163], v[88:91]
    v_mfma_f32_16x16x32_bf16 v[92:95], v[196:199], v[164:167], v[92:95]
    v_mfma_f32_16x16x32_bf16 v[96:99], v[196:199], v[168:171], v[96:99]
    v_mfma_f32_16x16x32_bf16 v[100:103], v[196:199], v[172:175], v[100:103]
    s_nop 4
    v_cvt_pk_bf16_f32 v88, v88, v89
    v_cvt_pk_bf16_f32 v89, v90, v91
    v_mfma_f32_16x16x32_bf16 v[4:7], v[184:187], v[156:159], v[4:7]
    ds_write_b64 v214, v[88:89] offset:0
    v_cvt_pk_bf16_f32 v92, v92, v93
    v_mfma_f32_16x16x32_bf16 v[32:35], v[188:191], v[156:159], v[32:35]
    v_cvt_pk_bf16_f32 v93, v94, v95
    ds_write_b64 v214, v[92:93] offset:27520
    v_mfma_f32_16x16x32_bf16 v[8:11], v[184:187], v[160:163], v[8:11]
    v_cvt_pk_bf16_f32 v96, v96, v97
    v_cvt_pk_bf16_f32 v97, v98, v99
    v_mfma_f32_16x16x32_bf16 v[36:39], v[188:191], v[160:163], v[36:39]
    ds_write_b64 v214, v[96:97] offset:7808
    v_cvt_pk_bf16_f32 v100, v100, v101
    v_mfma_f32_16x16x32_bf16 v[64:67], v[192:195], v[160:163], v[64:67]
    v_cvt_pk_bf16_f32 v101, v102, v103
    ds_write_b64 v214, v[100:101] offset:35328
    v_mfma_f32_16x16x32_bf16 v[12:15], v[184:187], v[164:167], v[12:15]
    v_cvt_pk_bf16_f32 v4, v4, v5
    v_cvt_pk_bf16_f32 v5, v6, v7
    v_mfma_f32_16x16x32_bf16 v[40:43], v[136:139], v[112:115], v[40:43]
    ds_write_b64 v212, v[4:5] offset:0
    v_cvt_pk_bf16_f32 v32, v32, v33
    v_mfma_f32_16x16x32_bf16 v[68:71], v[140:143], v[112:115], v[68:71]
    v_cvt_pk_bf16_f32 v33, v34, v35
    ds_write_b64 v212, v[32:33] offset:32
    v_mfma_f32_16x16x32_bf16 v[40:43], v[188:191], v[164:167], v[40:43]
    v_cvt_pk_bf16_f32 v8, v8, v9
    v_cvt_pk_bf16_f32 v9, v10, v11
    v_mfma_f32_16x16x32_bf16 v[68:71], v[192:195], v[164:167], v[68:71]
    ds_write_b64 v213, v[8:9] offset:0
    v_cvt_pk_bf16_f32 v36, v36, v37
    v_mfma_f32_16x16x32_bf16 v[16:19], v[132:135], v[116:119], v[16:19]
    v_cvt_pk_bf16_f32 v37, v38, v39
    ds_write_b64 v213, v[36:37] offset:32
    v_mfma_f32_16x16x32_bf16 v[44:47], v[136:139], v[116:119], v[44:47]
    v_cvt_pk_bf16_f32 v64, v64, v65
    v_cvt_pk_bf16_f32 v65, v66, v67
    v_mfma_f32_16x16x32_bf16 v[16:19], v[184:187], v[168:171], v[16:19]
    ds_write_b64 v213, v[64:65] offset:64
    v_cvt_pk_bf16_f32 v12, v12, v13
    v_mfma_f32_16x16x32_bf16 v[44:47], v[188:191], v[168:171], v[44:47]
    v_cvt_pk_bf16_f32 v13, v14, v15
    ds_write_b64 v213, v[12:13] offset:27520
    v_mfma_f32_16x16x32_bf16 v[72:75], v[140:143], v[116:119], v[72:75]
    v_cvt_pk_bf16_f32 v40, v40, v41
    v_cvt_pk_bf16_f32 v41, v42, v43
    v_mfma_f32_16x16x32_bf16 v[20:23], v[132:135], v[120:123], v[20:23]
    ds_write_b64 v213, v[40:41] offset:27552
    v_cvt_pk_bf16_f32 v68, v68, v69
    v_mfma_f32_16x16x32_bf16 v[72:75], v[192:195], v[168:171], v[72:75]
    v_cvt_pk_bf16_f32 v69, v70, v71
    ds_write_b64 v213, v[68:69] offset:27584
    v_mfma_f32_16x16x32_bf16 v[20:23], v[184:187], v[172:175], v[20:23]
    v_cvt_pk_bf16_f32 v16, v16, v17
    v_cvt_pk_bf16_f32 v17, v18, v19
    v_mfma_f32_16x16x32_bf16 v[48:51], v[136:139], v[120:123], v[48:51]
    ds_write_b64 v213, v[16:17] offset:7808
    v_cvt_pk_bf16_f32 v44, v44, v45
    v_mfma_f32_16x16x32_bf16 v[76:79], v[140:143], v[120:123], v[76:79]
    v_cvt_pk_bf16_f32 v45, v46, v47
    ds_write_b64 v213, v[44:45] offset:7840
    v_mfma_f32_16x16x32_bf16 v[48:51], v[188:191], v[172:175], v[48:51]
    v_cvt_pk_bf16_f32 v72, v72, v73
    v_cvt_pk_bf16_f32 v73, v74, v75
    v_mfma_f32_16x16x32_bf16 v[76:79], v[192:195], v[172:175], v[76:79]
    ds_write_b64 v213, v[72:73] offset:7872
    v_cvt_pk_bf16_f32 v20, v20, v21
    v_mfma_f32_16x16x32_bf16 v[24:27], v[132:135], v[124:127], v[24:27]
    v_cvt_pk_bf16_f32 v21, v22, v23
    ds_write_b64 v213, v[20:21] offset:35328
    v_mfma_f32_16x16x32_bf16 v[52:55], v[136:139], v[124:127], v[52:55]
    v_cvt_pk_bf16_f32 v48, v48, v49
    v_cvt_pk_bf16_f32 v49, v50, v51
    v_mfma_f32_16x16x32_bf16 v[24:27], v[184:187], v[176:179], v[24:27]
    ds_write_b64 v213, v[48:49] offset:35360
    v_cvt_pk_bf16_f32 v76, v76, v77
    v_mfma_f32_16x16x32_bf16 v[52:55], v[188:191], v[176:179], v[52:55]
    v_cvt_pk_bf16_f32 v77, v78, v79
    ds_write_b64 v213, v[76:77] offset:35392
    v_mfma_f32_16x16x32_bf16 v[80:83], v[140:143], v[124:127], v[80:83]
    v_mfma_f32_16x16x32_bf16 v[28:31], v[132:135], v[128:131], v[28:31]
    s_nop 0
    v_cvt_pk_bf16_f32 v24, v24, v25
    v_cvt_pk_bf16_f32 v25, v26, v27
    v_mfma_f32_16x16x32_bf16 v[80:83], v[192:195], v[176:179], v[80:83]
    ds_write_b64 v213, v[24:25] offset:15616
    v_cvt_pk_bf16_f32 v52, v52, v53
    v_mfma_f32_16x16x32_bf16 v[28:31], v[184:187], v[180:183], v[28:31]
    v_cvt_pk_bf16_f32 v53, v54, v55
    ds_write_b64 v213, v[52:53] offset:15648
    v_mfma_f32_16x16x32_bf16 v[56:59], v[136:139], v[128:131], v[56:59]
    v_mfma_f32_16x16x32_bf16 v[84:87], v[140:143], v[128:131], v[84:87]
    s_nop 0
    v_cvt_pk_bf16_f32 v80, v80, v81
    v_cvt_pk_bf16_f32 v81, v82, v83
    v_mfma_f32_16x16x32_bf16 v[56:59], v[188:191], v[180:183], v[56:59]
    ds_write_b64 v213, v[80:81] offset:15680
    v_cvt_pk_bf16_f32 v28, v28, v29
    v_mfma_f32_16x16x32_bf16 v[84:87], v[192:195], v[180:183], v[84:87]
    v_cvt_pk_bf16_f32 v29, v30, v31
    ds_write_b64 v213, v[28:29] offset:43136
    v_mfma_f32_16x16x32_bf16 v[60:63], v[140:143], v[104:107], v[60:63]
    v_mfma_f32_16x16x32_bf16 v[60:63], v[192:195], v[156:159], v[60:63]
    s_nop 0
    v_cvt_pk_bf16_f32 v56, v56, v57
    v_cvt_pk_bf16_f32 v57, v58, v59
    ds_write_b64 v213, v[56:57] offset:43168
    v_cvt_pk_bf16_f32 v84, v84, v85
    v_cvt_pk_bf16_f32 v85, v86, v87
    ds_write_b64 v213, v[84:85] offset:43200
    s_nop 0
    v_cvt_pk_bf16_f32 v60, v60, v61
    v_cvt_pk_bf16_f32 v61, v62, v63
    ds_write_b64 v212, v[60:61] offset:64
    s_branch L_wj_8
L_w3_7:
    v_mfma_f32_16x16x32_bf16 v[88:91], v[196:199], v[176:179], v[88:91]
    v_mfma_f32_16x16x32_bf16 v[92:95], v[196:199], v[180:183], v[92:95]
    v_mfma_f32_16x16x32_bf16 v[96:99], v[200:203], v[176:179], v[96:99]
    v_mfma_f32_16x16x32_bf16 v[100:103], v[200:203], v[180:183], v[100:103]
    s_nop 4
    v_cvt_pk_bf16_f32 v88, v88, v89
    v_cvt_pk_bf16_f32 v89, v90, v91
    v_mfma_f32_16x16x32_bf16 v[4:7], v[204:207], v[176:179], v[4:7]
    ds_write_b64 v214, v[88:89] offset:15616
    v_cvt_pk_bf16_f32 v92, v92, v93
    v_mfma_f32_16x16x32_bf16 v[32:35], v[204:207], v[180:183], v[32:35]
    v_cvt_pk_bf16_f32 v93, v94, v95
    ds_write_b64 v214, v[92:93] offset:43136
    v_mfma_f32_16x16x32_bf16 v[8:11], v[184:187], v[160:163], v[8:11]
    v_cvt_pk_bf16_f32 v96, v96, v97
    v_cvt_pk_bf16_f32 v97, v98, v99
    v_mfma_f32_16x16x32_bf16 v[36:39], v[188:191], v[160:163], v[36:39]
    ds_write_b64 v214, v[96:97] offset:15648
    v_cvt_pk_bf16_f32 v100, v100, v101
    v_mfma_f32_16x16x32_bf16 v[64:67], v[192:195], v[160:163], v[64:67]
    v_cvt_pk_bf16_f32 v101, v102, v103
    ds_write_b64 v214, v[100:101] offset:43168
    v_mfma_f32_16x16x32_bf16 v[12:15], v[184:187], v[164:167], v[12:15]
    v_cvt_pk_bf16_f32 v4, v4, v5
    v_cvt_pk_bf16_f32 v5, v6, v7
    v_mfma_f32_16x16x32_bf16 v[40:43], v[136:139], v[112:115], v[40:43]
    ds_write_b64 v214, v[4:5] offset:15680
    v_cvt_pk_bf16_f32 v32, v32, v33
    v_mfma_f32_16x16x32_bf16 v[68:71], v[140:143], v[112:115], v[68:71]
    v_cvt_pk_bf16_f32 v33, v34, v35
    ds_write_b64 v214, v[32:33] offset:43200
    v_mfma_f32_16x16x32_bf16 v[40:43], v[188:191], v[164:167], v[40:43]
    v_cvt_pk_bf16_f32 v8, v8, v9
    v_cvt_pk_bf16_f32 v9, v10, v11
    v_mfma_f32_16x16x32_bf16 v[68:71], v[192:195], v[164:167], v[68:71]
    ds_write_b64 v213, v[8:9] offset:0
    v_cvt_pk_bf16_f32 v36, v36, v37
    v_mfma_f32_16x16x32_bf16 v[16:19], v[132:135], v[116:119], v[16:19]
    v_cvt_pk_bf16_f32 v37, v38, v39
    ds_write_b64 v213, v[36:37] offset:32
    v_mfma_f32_16x16x32_bf16 v[44:47], v[136:139], v[116:119], v[44:47]
    v_cvt_pk_bf16_f32 v64, v64, v65
    v_cvt_pk_bf16_f32 v65, v66, v67
    v_mfma_f32_16x16x32_bf16 v[16:19], v[184:187], v[168:171], v[16:19]
    ds_write_b64 v213, v[64:65] offset:64
    v_cvt_pk_bf16_f32 v12, v12, v13
    v_mfma_f32_16x16x32_bf16 v[44:47], v[188:191], v[168:171], v[44:47]
    v_cvt_pk_bf16_f32 v13, v14, v15
    ds_write_b64 v213, v[12:13] offset:27520
    v_mfma_f32_16x16x32_bf16 v[72:75], v[140:143], v[116:119], v[72:75]
    v_cvt_pk_bf16_f32 v40, v40, v41
    v_cvt_pk_bf16_f32 v41, v42, v43
    v_mfma_f32_16x16x32_bf16 v[20:23], v[132:135], v[120:123], v[20:23]
    ds_write_b64 v213, v[40:41] offset:27552
    v_cvt_pk_bf16_f32 v68, v68, v69
    v_mfma_f32_16x16x32_bf16 v[72:75], v[192:195], v[168:171], v[72:75]
    v_cvt_pk_bf16_f32 v69, v70, v71
    ds_write_b64 v213, v[68:69] offset:27584
    v_mfma_f32_16x16x32_bf16 v[20:23], v[184:187], v[172:175], v[20:23]
    v_cvt_pk_bf16_f32 v16, v16, v17
    v_cvt_pk_bf16_f32 v17, v18, v19
    v_mfma_f32_16x16x32_bf16 v[48:51], v[136:139], v[120:123], v[48:51]
    ds_write_b64 v213, v[16:17] offset:7808
    v_cvt_pk_bf16_f32 v44, v44, v45
    v_mfma_f32_16x16x32_bf16 v[76:79], v[140:143], v[120:123], v[76:79]
    v_cvt_pk_bf16_f32 v45, v46, v47
    ds_write_b64 v213, v[44:45] offset:7840
    v_mfma_f32_16x16x32_bf16 v[48:51], v[188:191], v[172:175], v[48:51]
    v_cvt_pk_bf16_f32 v72, v72, v73
    v_cvt_pk_bf16_f32 v73, v74, v75
    v_mfma_f32_16x16x32_bf16 v[76:79], v[192:195], v[172:175], v[76:79]
    ds_write_b64 v213, v[72:73] offset:7872
    v_cvt_pk_bf16_f32 v20, v20, v21
    v_mfma_f32_16x16x32_bf16 v[24:27], v[132:135], v[124:127], v[24:27]
    v_cvt_pk_bf16_f32 v21, v22, v23
    ds_write_b64 v213, v[20:21] offset:35328
    v_mfma_f32_16x16x32_bf16 v[52:55], v[136:139], v[124:127], v[52:55]
    v_cvt_pk_bf16_f32 v48, v48, v49
    v_cvt_pk_bf16_f32 v49, v50, v51
    v_mfma_f32_16x16x32_bf16 v[24:27], v[184:187], v[176:179], v[24:27]
    ds_write_b64 v213, v[48:49] offset:35360
    v_cvt_pk_bf16_f32 v76, v76, v77
    v_mfma_f32_16x16x32_bf16 v[52:55], v[188:191], v[176:179], v[52:55]
    v_cvt_pk_bf16_f32 v77, v78, v79
    ds_write_b64 v213, v[76:77] offset:35392
    v_mfma_f32_16x16x32_bf16 v[80:83], v[140:143], v[124:127], v[80:83]
    v_mfma_f32_16x16x32_bf16 v[28:31], v[132:135], v[128:131], v[28:31]
    s_nop 0
    v_cvt_pk_bf16_f32 v24, v24, v25
    v_cvt_pk_bf16_f32 v25, v26, v27
    v_mfma_f32_16x16x32_bf16 v[80:83], v[192:195], v[176:179], v[80:83]
    ds_write_b64 v213, v[24:25] offset:15616
    v_cvt_pk_bf16_f32 v52, v52, v53
    v_mfma_f32_16x16x32_bf16 v[28:31], v[184:187], v[180:183], v[28:31]
    v_cvt_pk_bf16_f32 v53, v54, v55
    ds_write_b64 v213, v[52:53] offset:15648
    v_mfma_f32_16x16x32_bf16 v[56:59], v[136:139], v[128:131], v[56:59]
    v_mfma_f32_16x16x32_bf16 v[84:87], v[140:143], v[128:131], v[84:87]
    s_nop 0
    v_cvt_pk_bf16_f32 v80, v80, v81
    v_cvt_pk_bf16_f32 v81, v82, v83
    v_mfma_f32_16x16x32_bf16 v[56:59], v[188:191], v[180:183], v[56:59]
    ds_write_b64 v213, v[80:81] offset:15680
    v_cvt_pk_bf16_f32 v28, v28, v29
    v_mfma_f32_16x16x32_bf16 v[84:87], v[192:195], v[180:183], v[84:87]
    v_cvt_pk_bf16_f32 v29, v30, v31
    ds_write_b64 v213, v[28:29] offset:43136
    v_mfma_f32_16x16x32_bf16 v[60:63], v[140:143], v[104:107], v[60:63]
    v_mfma_f32_16x16x32_bf16 v[60:63], v[192:195], v[156:159], v[60:63]
    s_nop 0
    v_cvt_pk_bf16_f32 v56, v56, v57
    v_cvt_pk_bf16_f32 v57, v58, v59
    ds_write_b64 v213, v[56:57] offset:43168
    v_cvt_pk_bf16_f32 v84, v84, v85
    v_cvt_pk_bf16_f32 v85, v86, v87
    ds_write_b64 v213, v[84:85] offset:43200
    s_nop 0
    v_cvt_pk_bf16_f32 v60, v60, v61
    v_cvt_pk_bf16_f32 v61, v62, v63
    ds_write_b64 v212, v[60:61] offset:64
L_wj_8:
    s_waitcnt lgkmcnt(0)
    s_barrier
L_att:
    buffer_load_dword v249, v248, s[40:43], 0 offen sc1
    ds_read_b64 v[4:5], v215 offset:3904
    ds_read_b64 v[16:17], v215 offset:160
    ds_read_b64 v[26:27], v215 offset:2112
    ds_read_b64 v[36:37], v215 offset:4064
    ds_read_b64 v[6:7], v215 offset:3912
    ds_read_b64 v[18:19], v215 offset:168
    ds_read_b64 v[28:29], v215 offset:2120
    ds_read_b64 v[38:39], v215 offset:4072
    ds_read_b64 v[8:9], v215 offset:3920
    ds_read_b64 v[20:21], v215 offset:176
    ds_read_b64 v[30:31], v215 offset:2128
    ds_read_b64 v[40:41], v215 offset:4080
    ds_read_b64 v[10:11], v215 offset:3928
    ds_read_b64 v[22:23], v215 offset:184
    ds_read_b64 v[32:33], v215 offset:2136
    ds_read_b64 v[42:43], v215 offset:4088
    ds_read_b64 v[12:13], v215 offset:3936
    ds_read_b64 v[24:25], v215 offset:192
    ds_read_b64 v[34:35], v215 offset:2144
    ds_read_b64 v[44:45], v215 offset:4096
    s_waitcnt lgkmcnt(15)
    v_mfma_f32_4x4x4_16b_bf16 v[80:83], v[16:17], v[4:5], 0
    v_mfma_f32_4x4x4_16b_bf16 v[84:87], v[26:27], v[4:5], 0
    v_mfma_f32_4x4x4_16b_bf16 v[88:91], v[36:37], v[4:5], 0
    ds_read_b64_tr_b16 v[48:49], v216 offset:0
    ds_read_b64_tr_b16 v[50:51], v216 offset:1952
    ds_read_b64_tr_b16 v[52:53], v216 offset:3904
    s_waitcnt lgkmcnt(15)
    v_mfma_f32_4x4x4_16b_bf16 v[80:83], v[18:19], v[6:7], v[80:83]
    v_mfma_f32_4x4x4_16b_bf16 v[84:87], v[28:29], v[6:7], v[84:87]
    v_mfma_f32_4x4x4_16b_bf16 v[88:91], v[38:39], v[6:7], v[88:91]
    ds_read_b64_tr_b16 v[54:55], v216 offset:8
    ds_read_b64_tr_b16 v[56:57], v216 offset:1960
    ds_read_b64_tr_b16 v[58:59], v216 offset:3912
    s_waitcnt lgkmcnt(14)
    v_mfma_f32_4x4x4_16b_bf16 v[80:83], v[20:21], v[8:9], v[80:83]
    v_mfma_f32_4x4x4_16b_bf16 v[84:87], v[30:31], v[8:9], v[84:87]
    v_mfma_f32_4x4x4_16b_bf16 v[88:91], v[40:41], v[8:9], v[88:91]
    ds_read_b64_tr_b16 v[60:61], v216 offset:16
    ds_read_b64_tr_b16 v[62:63], v216 offset:1968
    ds_read_b64_tr_b16 v[64:65], v216 offset:3920
    s_waitcnt lgkmcnt(13)
    v_mfma_f32_4x4x4_16b_bf16 v[80:83], v[22:23], v[10:11], v[80:83]
    v_mfma_f32_4x4x4_16b_bf16 v[84:87], v[32:33], v[10:11], v[84:87]
    v_mfma_f32_4x4x4_16b_bf16 v[88:91], v[42:43], v[10:11], v[88:91]
    ds_read_b64_tr_b16 v[66:67], v216 offset:24
    ds_read_b64_tr_b16 v[68:69], v216 offset:1976
    ds_read_b64_tr_b16 v[70:71], v216 offset:3928
    s_waitcnt lgkmcnt(12)
    v_mfma_f32_4x4x4_16b_bf16 v[80:83], v[24:25], v[12:13], v[80:83]
    v_mfma_f32_4x4x4_16b_bf16 v[84:87], v[34:35], v[12:13], v[84:87]
    v_mfma_f32_4x4x4_16b_bf16 v[88:91], v[44:45], v[12:13], v[88:91]
    ds_read_b64_tr_b16 v[72:73], v217 offset:0
    ds_read_b64_tr_b16 v[74:75], v217 offset:1952
    ds_read_b64_tr_b16 v[76:77], v217 offset:3904
    v_mov_b32 v98, s93
    v_cndmask_b32 v81, v98, v81, s[44:45]
    v_cndmask_b32 v82, v98, v82, s[46:47]
    v_cndmask_b32 v83, v98, v83, s[48:49]
    v_cndmask_b32 v89, v98, v89, s[60:61]
    v_cndmask_b32 v90, v98, v90, s[62:63]
    v_cndmask_b32 v91, v98, v91, s[64:65]
    s_cmp_eq_u64 s[50:51], exec
    s_cbranch_scc1 L_nomask_9
    v_cndmask_b32 v84, v98, v84, s[50:51]
    v_cndmask_b32 v85, v98, v85, s[52:53]
    v_cndmask_b32 v86, v98, v86, s[54:55]
    v_cndmask_b32 v87, v98, v87, s[56:57]
L_nomask_9:
    v_max3_f32 v92, v81, v82, v83
    v_max3_f32 v93, v84, v85, v86
    v_max3_f32 v94, v87, v88, v89
    v_max3_f32 v92, v92, v90, v91
    v_max3_f32 v92, v92, v93, v94
    v_mul_f32 v92, s90, v92
    v_pk_fma_f32 v[80:81], v[80:81], s[90:91], v[92:93] op_sel_hi:[1,1,0] neg_lo:[0,0,1] neg_hi:[0,0,1]
    v_pk_fma_f32 v[82:83], v[82:83], s[90:91], v[92:93] op_sel_hi:[1,1,0] neg_lo:[0,0,1] neg_hi:[0,0,1]
    v_pk_fma_f32 v[84:85], v[84:85], s[90:91], v[92:93] op_sel_hi:[1,1,0] neg_lo:[0,0,1] neg_hi:[0,0,1]
    v_pk_fma_f32 v[86:87], v[86:87], s[90:91], v[92:93] op_sel_hi:[1,1,0] neg_lo:[0,0,1] neg_hi:[0,0,1]
    v_pk_fma_f32 v[88:89], v[88:89], s[90:91], v[92:93] op_sel_hi:[1,1,0] neg_lo:[0,0,1] neg_hi:[0,0,1]
    v_pk_fma_f32 v[90:91], v[90:91], s[90:91], v[92:93] op_sel_hi:[1,1,0] neg_lo:[0,0,1] neg_hi:[0,0,1]
    v_mov_b32 v80, 0
    v_exp_f32 v81, v81
    v_exp_f32 v82, v82
    v_exp_f32 v83, v83
    v_exp_f32 v84, v84
    v_exp_f32 v85, v85
    v_exp_f32 v86, v86
    v_exp_f32 v87, v87
    v_exp_f32 v88, v88
    v_exp_f32 v89, v89
    v_exp_f32 v90, v90
    v_exp_f32 v91, v91
    v_pk_add_f32 v[92:93], v[80:81], v[82:83]
    v_pk_add_f32 v[94:95], v[84:85], v[86:87]
    v_pk_add_f32 v[96:97], v[88:89], v[90:91]
    v_pk_add_f32 v[92:93], v[92:93], v[94:95]
    v_pk_add_f32 v[92:93], v[92:93], v[96:97]
    v_add_f32 v92, v92, v93
    v_rcp_f32 v92, v92
    s_nop 0
    v_pk_mul_f32 v[80:81], v[80:81], v[92:93] op_sel_hi:[1,0]
    v_pk_mul_f32 v[82:83], v[82:83], v[92:93] op_sel_hi:[1,0]
    v_pk_mul_f32 v[84:85], v[84:85], v[92:93] op_sel_hi:[1,0]
    v_pk_mul_f32 v[86:87], v[86:87], v[92:93] op_sel_hi:[1,0]
    v_pk_mul_f32 v[88:89], v[88:89], v[92:93] op_sel_hi:[1,0]
    v_pk_mul_f32 v[90:91], v[90:91], v[92:93] op_sel_hi:[1,0]
    v_cvt_pk_bf16_f32 v124, v80, v81
    v_cvt_pk_bf16_f32 v125, v82, v83
    v_cvt_pk_bf16_f32 v126, v84, v85
    v_cvt_pk_bf16_f32 v127, v86, v87
    v_cvt_pk_bf16_f32 v128, v88, v89
    v_cvt_pk_bf16_f32 v129, v90, v91
    s_waitcnt lgkmcnt(0)
    v_mfma_f32_4x4x4_16b_bf16 v[120:123], v[72:73], v[124:125], 0
    v_mfma_f32_4x4x4_16b_bf16 v[104:107], v[48:49], v[124:125], 0
    v_mfma_f32_4x4x4_16b_bf16 v[108:111], v[54:55], v[124:125], 0
    v_mfma_f32_4x4x4_16b_bf16 v[112:115], v[60:61], v[124:125], 0
    v_mfma_f32_4x4x4_16b_bf16 v[116:119], v[66:67], v[124:125], 0
    v_mfma_f32_4x4x4_16b_bf16 v[120:123], v[74:75], v[126:127], v[120:123]
    v_mfma_f32_4x4x4_16b_bf16 v[104:107], v[50:51], v[126:127], v[104:107]
    v_mfma_f32_4x4x4_16b_bf16 v[108:111], v[56:57], v[126:127], v[108:111]
    v_mfma_f32_4x4x4_16b_bf16 v[112:115], v[62:63], v[126:127], v[112:115]
    v_mfma_f32_4x4x4_16b_bf16 v[116:119], v[68:69], v[126:127], v[116:119]
    v_mfma_f32_4x4x4_16b_bf16 v[120:123], v[76:77], v[128:129], v[120:123]
    v_mfma_f32_4x4x4_16b_bf16 v[104:107], v[52:53], v[128:129], v[104:107]
    v_mfma_f32_4x4x4_16b_bf16 v[108:111], v[58:59], v[128:129], v[108:111]
    v_mfma_f32_4x4x4_16b_bf16 v[112:115], v[64:65], v[128:129], v[112:115]
    v_mfma_f32_4x4x4_16b_bf16 v[116:119], v[70:71], v[128:129], v[116:119]
    s_waitcnt vmcnt(0)
    v_cvt_pk_bf16_f32 v140, v120, v121
    v_cvt_pk_bf16_f32 v141, v122, v123
    v_cvt_pk_bf16_f32 v132, v104, v105
    v_cvt_pk_bf16_f32 v133, v106, v107
    v_cvt_pk_bf16_f32 v134, v108, v109
    v_cvt_pk_bf16_f32 v135, v110, v111
    buffer_store_dwordx4 v[132:135], v218, s[32:35], 0 offen sc1
    v_cvt_pk_bf16_f32 v136, v112, v113
    v_cvt_pk_bf16_f32 v137, v114, v115
    v_cvt_pk_bf16_f32 v138, v116, v117
    v_cvt_pk_bf16_f32 v139, v118, v119
    buffer_store_dwordx4 v[136:139], v218, s[32:35], 0 offen offset:256 sc1
    v_permlane32_swap_b32 v140, v142
    v_permlane32_swap_b32 v141, v143
    buffer_store_dwordx4 v[140:143], v219, s[32:35], 0 offen sc1
    s_barrier
    s_cmp_ge_u32 s18, 4
    s_cbranch_scc1 L_a_leave
    ds_read_b64_tr_b16 v[16:17], v252 offset:0
    ds_read_b64_tr_b16 v[18:19], v252 offset:2560
    ds_read_b64_tr_b16 v[20:21], v252 offset:32
    ds_read_b64_tr_b16 v[22:23], v252 offset:2592
    ds_read_b64_tr_b16 v[24:25], v252 offset:64
    ds_read_b64_tr_b16 v[26:27], v252 offset:2624
    ds_read_b64_tr_b16 v[28:29], v252 offset:96
    ds_read_b64_tr_b16 v[30:31], v252 offset:2656
    ds_read_b64_tr_b16 v[32:33], v252 offset:128
    ds_read_b64_tr_b16 v[34:35], v252 offset:2688
    ds_read_b64_tr_b16 v[36:37], v252 offset:5120
    ds_read_b64_tr_b16 v[38:39], v252 offset:7680
    ds_read_b64_tr_b16 v[40:41], v252 offset:5152
    ds_read_b64_tr_b16 v[42:43], v252 offset:7712
    ds_read_b64_tr_b16 v[44:45], v252 offset:5184
    ds_read_b64_tr_b16 v[46:47], v252 offset:7744
    ds_read_b64_tr_b16 v[48:49], v252 offset:5216
    ds_read_b64_tr_b16 v[50:51], v252 offset:7776
    ds_read_b64_tr_b16 v[52:53], v252 offset:5248
    ds_read_b64_tr_b16 v[54:55], v252 offset:7808
    ds_read_b64_tr_b16 v[56:57], v252 offset:10240
    ds_read_b64_tr_b16 v[58:59], v252 offset:12800
    ds_read_b64_tr_b16 v[60:61], v252 offset:10272
    ds_read_b64_tr_b16 v[62:63], v252 offset:12832
    ds_read_b64_tr_b16 v[64:65], v252 offset:10304
    ds_read_b64_tr_b16 v[66:67], v252 offset:12864
    ds_read_b64_tr_b16 v[68:69], v252 offset:10336
    ds_read_b64_tr_b16 v[70:71], v252 offset:12896
    ds_read_b64_tr_b16 v[72:73], v252 offset:10368
    ds_read_b64_tr_b16 v[74:75], v252 offset:12928
    ds_read_b64_tr_b16 v[76:77], v252 offset:15360
    ds_read_b64_tr_b16 v[78:79], v252 offset:17920
    ds_read_b64_tr_b16 v[80:81], v252 offset:15392
    ds_read_b64_tr_b16 v[82:83], v252 offset:17952
    ds_read_b64_tr_b16 v[84:85], v252 offset:15424
    ds_read_b64_tr_b16 v[86:87], v252 offset:17984
    ds_read_b64_tr_b16 v[88:89], v252 offset:15456
    ds_read_b64_tr_b16 v[90:91], v252 offset:18016
    ds_read_b64_tr_b16 v[92:93], v252 offset:15488
    ds_read_b64_tr_b16 v[94:95], v252 offset:18048
    ds_read_b64_tr_b16 v[96:97], v252 offset:20480
    ds_read_b64_tr_b16 v[98:99], v252 offset:23040
    ds_read_b64_tr_b16 v[100:101], v252 offset:20512
    ds_read_b64_tr_b16 v[102:103], v252 offset:23072
    ds_read_b64_tr_b16 v[104:105], v252 offset:20544
    ds_read_b64_tr_b16 v[106:107], v252 offset:23104
    ds_read_b64_tr_b16 v[108:109], v252 offset:20576
    ds_read_b64_tr_b16 v[110:111], v252 offset:23136
    ds_read_b64_tr_b16 v[112:113], v252 offset:20608
    ds_read_b64_tr_b16 v[114:115], v252 offset:23168
    ds_read_b64_tr_b16 v[144:145], v252 offset:25600
    ds_read_b64_tr_b16 v[146:147], v252 offset:28160
    ds_read_b64_tr_b16 v[148:149], v252 offset:25632
    ds_read_b64_tr_b16 v[150:151], v252 offset:28192
    ds_read_b64_tr_b16 v[152:153], v252 offset:25664
    ds_read_b64_tr_b16 v[154:155], v252 offset:28224
    ds_read_b64_tr_b16 v[156:157], v252 offset:25696
    ds_read_b64_tr_b16 v[158:159], v252 offset:28256
    ds_read_b64_tr_b16 v[160:161], v252 offset:25728
    ds_read_b64_tr_b16 v[162:163], v252 offset:28288
    ds_read_b64_tr_b16 v[164:165], v252 offset:30720
    ds_read_b64_tr_b16 v[166:167], v252 offset:33280
    ds_read_b64_tr_b16 v[168:169], v252 offset:30752
    ds_read_b64_tr_b16 v[170:171], v252 offset:33312
    ds_read_b64_tr_b16 v[172:173], v252 offset:30784
    ds_read_b64_tr_b16 v[174:175], v252 offset:33344
    ds_read_b64_tr_b16 v[176:177], v252 offset:30816
    ds_read_b64_tr_b16 v[178:179], v252 offset:33376
    ds_read_b64_tr_b16 v[180:181], v252 offset:30848
    ds_read_b64_tr_b16 v[182:183], v252 offset:33408
    ds_read_b64_tr_b16 v[116:117], v252 offset:35840
    ds_read_b64_tr_b16 v[118:119], v252 offset:38400
    ds_read_b64_tr_b16 v[120:121], v252 offset:35872
    ds_read_b64_tr_b16 v[122:123], v252 offset:38432
    ds_read_b64_tr_b16 v[124:125], v252 offset:35904
    ds_read_b64_tr_b16 v[126:127], v252 offset:38464
    ds_read_b64_tr_b16 v[128:129], v252 offset:35936
    ds_read_b64_tr_b16 v[130:131], v252 offset:38496
    ds_read_b64_tr_b16 v[132:133], v252 offset:35968
    ds_read_b64_tr_b16 v[134:135], v252 offset:38528
    s_mov_b32 s77, 0
L_rdy_10:
    v_readfirstlane_b32 s76, v249
    s_nop 2
    s_cmp_lg_u32 s76, 0
    s_cbranch_scc1 L_rdy_ok_11
    s_add_u32 s77, s77, 1
    s_cmp_gt_u32 s77, 20000
    s_cbranch_scc1 L_rdy_ok_11
    s_sleep 2
    buffer_load_dword v249, v248, s[40:43], 0 offen sc1
    s_waitcnt vmcnt(0)
    s_branch L_rdy_10
L_rdy_ok_11:
    v_mov_b32 v249, 1
    s_lshl_b32 s73, s85, 3
    s_add_u32 s73, s73, s84
    s_lshl_b32 s73, s73, 7
    s_add_u32 s73, s73, 6815744
    s_waitcnt vmcnt(0) lgkmcnt(0)
    s_barrier
    s_cmp_lg_u32 s18, 0
    s_cbranch_scc1 L_A2
    s_mov_b64 exec, 1
    buffer_store_dword v249, v248, s[32:35], s73 offen sc1
    s_branch L_A2
L_a_leave:
    s_waitcnt vmcnt(0)
    s_barrier
    s_endpgm
L_A2:
    s_mov_b32 s77, 0
    s_mov_b64 exec, 0xff
L_pollo_56:
    buffer_load_dword v1, v254, s[32:35], s83 offen sc1
    s_waitcnt vmcnt(0)
    v_cmp_ne_u32 vcc, 1, v1
    s_add_u32 s77, s77, 1
    s_cbranch_vccz L_pollo_ok_57
    s_nop 0
    s_cmp_lg_u32 vcc_lo, 0xff
    s_cbranch_scc1 L_pollo_ok_57_t
    s_sleep 6
L_pollo_ok_57_t:
    s_cmp_gt_u32 s77, 20000
    s_cbranch_scc0 L_pollo_56
L_pollo_ok_57:
    s_mov_b64 exec, -1
    buffer_load_dwordx4 v[204:207], v250, s[32:35], s78 offen offset:0 sc1
    buffer_load_dwordx4 v[208:211], v250, s[32:35], s78 offen offset:1024 sc1
    buffer_load_dwordx4 v[212:215], v250, s[32:35], s78 offen offset:2048 sc1
    buffer_load_dwordx4 v[216:219], v250, s[32:35], s78 offen offset:3072 sc1
    buffer_load_dwordx4 v[220:223], v250, s[32:35], s79 offen offset:0 sc1
    buffer_load_dwordx4 v[4:7], v250, s[32:35], s79 offen offset:1024 sc1
    buffer_load_dwordx4 v[8:11], v250, s[32:35], s79 offen offset:2048 sc1
    buffer_load_dwordx4 v[12:15], v250, s[32:35], s79 offen offset:3072 sc1
    s_waitcnt lgkmcnt(0)
    ds_read_b64_tr_b16 v[230:231], v251 offset:0
    ds_read_b64_tr_b16 v[232:233], v251 offset:2560
    ds_read_b64_tr_b16 v[234:235], v251 offset:32
    ds_read_b64_tr_b16 v[236:237], v251 offset:2592
    ds_read_b64_tr_b16 v[238:239], v251 offset:64
    ds_read_b64_tr_b16 v[240:241], v251 offset:2624
    ds_read_b64_tr_b16 v[242:243], v251 offset:96
    ds_read_b64_tr_b16 v[244:245], v251 offset:2656
    ds_read_b64_tr_b16 v[246:247], v251 offset:128
    ds_read_b64_tr_b16 v[248:249], v251 offset:2688
    s_waitcnt vmcnt(7)
    v_mfma_f32_16x16x32_bf16 v[184:187], v[16:19], v[204:207], 0
    v_mfma_f32_16x16x32_bf16 v[188:191], v[20:23], v[204:207], 0
    v_mfma_f32_16x16x32_bf16 v[192:195], v[24:27], v[204:207], 0
    v_mfma_f32_16x16x32_bf16 v[196:199], v[28:31], v[204:207], 0
    v_mfma_f32_16x16x32_bf16 v[200:203], v[32:35], v[204:207], 0
    s_waitcnt vmcnt(6)
    v_mfma_f32_16x16x32_bf16 v[184:187], v[36:39], v[208:211], v[184:187]
    buffer_load_dwordx4 v[204:207], v250, s[32:35], s80 offen offset:0 sc1
    ds_read_b64_tr_b16 v[16:17], v251 offset:5120
    v_mfma_f32_16x16x32_bf16 v[188:191], v[40:43], v[208:211], v[188:191]
    ds_read_b64_tr_b16 v[18:19], v251 offset:7680
    ds_read_b64_tr_b16 v[20:21], v251 offset:5152
    v_mfma_f32_16x16x32_bf16 v[192:195], v[44:47], v[208:211], v[192:195]
    ds_read_b64_tr_b16 v[22:23], v251 offset:7712
    v_mfma_f32_16x16x32_bf16 v[196:199], v[48:51], v[208:211], v[196:199]
    ds_read_b64_tr_b16 v[24:25], v251 offset:5184
    ds_read_b64_tr_b16 v[26:27], v251 offset:7744
    v_mfma_f32_16x16x32_bf16 v[200:203], v[52:55], v[208:211], v[200:203]
    ds_read_b64_tr_b16 v[28:29], v251 offset:5216
    s_waitcnt vmcnt(6)
    v_mfma_f32_16x16x32_bf16 v[184:187], v[56:59], v[212:215], v[184:187]
    buffer_load_dwordx4 v[208:211], v250, s[32:35], s80 offen offset:1024 sc1
    ds_read_b64_tr_b16 v[30:31], v251 offset:7776
    v_mfma_f32_16x16x32_bf16 v[188:191], v[60:63], v[212:215], v[188:191]
    ds_read_b64_tr_b16 v[32:33], v251 offset:5248
    ds_read_b64_tr_b16 v[34:35], v251 offset:7808
    v_mfma_f32_16x16x32_bf16 v[192:195], v[64:67], v[212:215], v[192:195]
    ds_read_b64_tr_b16 v[36:37], v251 offset:10240
    v_mfma_f32_16x16x32_bf16 v[196:199], v[68:71], v[212:215], v[196:199]
    ds_read_b64_tr_b16 v[38:39], v251 offset:12800
    ds_read_b64_tr_b16 v[40:41], v251 offset:10272
    v_mfma_f32_16x16x32_bf16 v[200:203], v[72:75], v[212:215], v[200:203]
    ds_read_b64_tr_b16 v[42:43], v251 offset:12832
    s_waitcnt vmcnt(6)
    v_mfma_f32_16x16x32_bf16 v[184:187], v[76:79], v[216:219], v[184:187]
    buffer_load_dwordx4 v[212:215], v250, s[32:35], s80 offen offset:2048 sc1
    ds_read_b64_tr_b16 v[44:45], v251 offset:10304
    v_mfma_f32_16x16x32_bf16 v[188:191], v[80:83], v[216:219], v[188:191]
    ds_read_b64_tr_b16 v[46:47], v251 offset:12864
    ds_read_b64_tr_b16 v[48:49], v251 offset:10336
    v_mfma_f32_16x16x32_bf16 v[192:195], v[84:87], v[216:219], v[192:195]
    ds_read_b64_tr_b16 v[50:51], v251 offset:12896
    v_mfma_f32_16x16x32_bf16 v[196:199], v[88:91], v[216:219], v[196:199]
    ds_read_b64_tr_b16 v[52:53], v251 offset:10368
    ds_read_b64_tr_b16 v[54:55], v251 offset:12928
    v_mfma_f32_16x16x32_bf16 v[200:203], v[92:95], v[216:219], v[200:203]
    ds_read_b64_tr_b16 v[56:57], v251 offset:15360
    s_waitcnt vmcnt(6)
    v_mfma_f32_16x16x32_bf16 v[184:187], v[96:99], v[220:223], v[184:187]
    buffer_load_dwordx4 v[216:219], v250, s[32:35], s80 offen offset:3072 sc1
    ds_read_b64_tr_b16 v[58:59], v251 offset:17920
    v_mfma_f32_16x16x32_bf16 v[188:191], v[100:103], v[220:223], v[188:191]
    ds_read_b64_tr_b16 v[60:61], v251 offset:15392
    ds_read_b64_tr_b16 v[62:63], v251 offset:17952
    v_mfma_f32_16x16x32_bf16 v[192:195], v[104:107], v[220:223], v[192:195]
    ds_read_b64_tr_b16 v[64:65], v251 offset:15424
    v_mfma_f32_16x16x32_bf16 v[196:199], v[108:111], v[220:223], v[196:199]
    ds_read_b64_tr_b16 v[66:67], v251 offset:17984
    ds_read_b64_tr_b16 v[68:69], v251 offset:15456
    v_mfma_f32_16x16x32_bf16 v[200:203], v[112:115], v[220:223], v[200:203]
    ds_read_b64_tr_b16 v[70:71], v251 offset:18016
    s_waitcnt vmcnt(6)
    v_mfma_f32_16x16x32_bf16 v[184:187], v[144:147], v[4:7], v[184:187]
    buffer_load_dwordx4 v[220:223], v250, s[32:35], s81 offen offset:0 sc1
    ds_read_b64_tr_b16 v[72:73], v251 offset:15488
    v_mfma_f32_16x16x32_bf16 v[188:191], v[148:151], v[4:7], v[188:191]
    ds_read_b64_tr_b16 v[74:75], v251 offset:18048
    ds_read_b64_tr_b16 v[76:77], v251 offset:20480
    v_mfma_f32_16x16x32_bf16 v[192:195], v[152:155], v[4:7], v[192:195]
    ds_read_b64_tr_b16 v[78:79], v251 offset:23040
    v_mfma_f32_16x16x32_bf16 v[196:199], v[156:159], v[4:7], v[196:199]
    ds_read_b64_tr_b16 v[80:81], v251 offset:20512
    ds_read_b64_tr_b16 v[82:83], v251 offset:23072
    v_mfma_f32_16x16x32_bf16 v[200:203], v[160:163], v[4:7], v[200:203]
    ds_read_b64_tr_b16 v[84:85], v251 offset:20544
    s_waitcnt vmcnt(6)
    v_mfma_f32_16x16x32_bf16 v[184:187], v[164:167], v[8:11], v[184:187]
    buffer_load_dwordx4 v[4:7], v250, s[32:35], s81 offen offset:1024 sc1
    ds_read_b64_tr_b16 v[86:87], v251 offset:23104
    v_mfma_f32_16x16x32_bf16 v[188:191], v[168:171], v[8:11], v[188:191]
    ds_read_b64_tr_b16 v[88:89], v251 offset:20576
    ds_read_b64_tr_b16 v[90:91], v251 offset:23136
    v_mfma_f32_16x16x32_bf16 v[192:195], v[172:175], v[8:11], v[192:195]
    ds_read_b64_tr_b16 v[92:93], v251 offset:20608
    v_mfma_f32_16x16x32_bf16 v[196:199], v[176:179], v[8:11], v[196:199]
    ds_read_b64_tr_b16 v[94:95], v251 offset:23168
    ds_read_b64_tr_b16 v[96:97], v251 offset:25600
    v_mfma_f32_16x16x32_bf16 v[200:203], v[180:183], v[8:11], v[200:203]
    ds_read_b64_tr_b16 v[98:99], v251 offset:28160
    s_waitcnt vmcnt(6)
    v_mfma_f32_16x16x32_bf16 v[184:187], v[116:119], v[12:15], v[184:187]
    buffer_load_dwordx4 v[8:11], v250, s[32:35], s81 offen offset:2048 sc1
    ds_read_b64_tr_b16 v[100:101], v251 offset:25632
    v_mfma_f32_16x16x32_bf16 v[188:191], v[120:123], v[12:15], v[188:191]
    ds_read_b64_tr_b16 v[102:103], v251 offset:28192
    ds_read_b64_tr_b16 v[104:105], v251 offset:25664
    v_mfma_f32_16x16x32_bf16 v[192:195], v[124:127], v[12:15], v[192:195]
    ds_read_b64_tr_b16 v[106:107], v251 offset:28224
    v_mfma_f32_16x16x32_bf16 v[196:199], v[128:131], v[12:15], v[196:199]
    ds_read_b64_tr_b16 v[108:109], v251 offset:25696
    ds_read_b64_tr_b16 v[110:111], v251 offset:28256
    v_mfma_f32_16x16x32_bf16 v[200:203], v[132:135], v[12:15], v[200:203]
    ds_read_b64_tr_b16 v[112:113], v251 offset:25728
    s_waitcnt vmcnt(6)
    s_waitcnt lgkmcnt(15)
    v_mfma_f32_16x16x32_bf16 v[184:187], v[230:233], v[204:207], v[184:187]
    buffer_load_dwordx4 v[12:15], v250, s[32:35], s81 offen offset:3072 sc1
    ds_read_b64_tr_b16 v[114:115], v251 offset:28288
    s_waitcnt lgkmcnt(15)
    v_mfma_f32_16x16x32_bf16 v[188:191], v[234:237], v[204:207], v[188:191]
    ds_read_b64_tr_b16 v[144:145], v251 offset:30720
    ds_read_b64_tr_b16 v[146:147], v251 offset:33280
    s_waitcnt lgkmcnt(15)
    v_mfma_f32_16x16x32_bf16 v[192:195], v[238:241], v[204:207], v[192:195]
    ds_read_b64_tr_b16 v[148:149], v251 offset:30752
    s_waitcnt lgkmcnt(15)
    v_mfma_f32_16x16x32_bf16 v[196:199], v[242:245], v[204:207], v[196:199]
    ds_read_b64_tr_b16 v[150:151], v251 offset:33312
    ds_read_b64_tr_b16 v[152:153], v251 offset:30784
    s_waitcnt lgkmcnt(15)
    v_mfma_f32_16x16x32_bf16 v[200:203], v[246:249], v[204:207], v[200:203]
    ds_read_b64_tr_b16 v[154:155], v251 offset:33344
    s_waitcnt vmcnt(6)
    s_waitcnt lgkmcnt(15)
    v_mfma_f32_16x16x32_bf16 v[184:187], v[16:19], v[208:211], v[184:187]
    buffer_load_dwordx4 v[204:207], v250, s[32:35], s82 offen offset:0 sc1
    ds_read_b64_tr_b16 v[156:157], v251 offset:30816
    s_waitcnt lgkmcnt(15)
    v_mfma_f32_16x16x32_bf16 v[188:191], v[20:23], v[208:211], v[188:191]
    ds_read_b64_tr_b16 v[158:159], v251 offset:33376
    ds_read_b64_tr_b16 v[160:161], v251 offset:30848
    s_waitcnt lgkmcnt(15)
    v_mfma_f32_16x16x32_bf16 v[192:195], v[24:27], v[208:211], v[192:195]
    ds_read_b64_tr_b16 v[162:163], v251 offset:33408
    s_waitcnt lgkmcnt(15)
    v_mfma_f32_16x16x32_bf16 v[196:199], v[28:31], v[208:211], v[196:199]
    ds_read_b64_tr_b16 v[164:165], v251 offset:35840
    ds_read_b64_tr_b16 v[166:167], v251 offset:38400
    s_waitcnt lgkmcnt(15)
    v_mfma_f32_16x16x32_bf16 v[200:203], v[32:35], v[208:211], v[200:203]
    ds_read_b64_tr_b16 v[168:169], v251 offset:35872
    s_waitcnt vmcnt(6)
    s_waitcnt lgkmcnt(15)
    v_mfma_f32_16x16x32_bf16 v[184:187], v[36:39], v[212:215], v[184:187]
    buffer_load_dwordx4 v[208:211], v250, s[32:35], s82 offen offset:1024 sc1
    ds_read_b64_tr_b16 v[170:171], v251 offset:38432
    s_waitcnt lgkmcnt(15)
    v_mfma_f32_16x16x32_bf16 v[188:191], v[40:43], v[212:215], v[188:191]
    ds_read_b64_tr_b16 v[172:173], v251 offset:35904
    ds_read_b64_tr_b16 v[174:175], v251 offset:38464
    s_waitcnt lgkmcnt(15)
    v_mfma_f32_16x16x32_bf16 v[192:195], v[44:47], v[212:215], v[192:195]
    ds_read_b64_tr_b16 v[176:177], v251 offset:35936
    s_waitcnt lgkmcnt(15)
    v_mfma_f32_16x16x32_bf16 v[196:199], v[48:51], v[212:215], v[196:199]
    ds_read_b64_tr_b16 v[178:179], v251 offset:38496
    ds_read_b64_tr_b16 v[180:181], v251 offset:35968
    s_waitcnt lgkmcnt(15)
    v_mfma_f32_16x16x32_bf16 v[200:203], v[52:55], v[212:215], v[200:203]
    ds_read_b64_tr_b16 v[182:183], v251 offset:38528
    s_waitcnt vmcnt(6)
    s_waitcnt lgkmcnt(15)
    v_mfma_f32_16x16x32_bf16 v[184:187], v[56:59], v[216:219], v[184:187]
    buffer_load_dwordx4 v[212:215], v250, s[32:35], s82 offen offset:2048 sc1
    ds_read_b64_tr_b16 v[116:117], v251 offset:40960
    s_waitcnt lgkmcnt(15)
    v_mfma_f32_16x16x32_bf16 v[188:191], v[60:63], v[216:219], v[188:191]
    ds_read_b64_tr_b16 v[118:119], v251 offset:43520
    ds_read_b64_tr_b16 v[120:121], v251 offset:40992
    s_waitcnt lgkmcnt(15)
    v_mfma_f32_16x16x32_bf16 v[192:195], v[64:67], v[216:219], v[192:195]
    ds_read_b64_tr_b16 v[122:123], v251 offset:43552
    s_waitcnt lgkmcnt(15)
    v_mfma_f32_16x16x32_bf16 v[196:199], v[68:71], v[216:219], v[196:199]
    ds_read_b64_tr_b16 v[124:125], v251 offset:41024
    ds_read_b64_tr_b16 v[126:127], v251 offset:43584
    s_waitcnt lgkmcnt(15)
    v_mfma_f32_16x16x32_bf16 v[200:203], v[72:75], v[216:219], v[200:203]
    ds_read_b64_tr_b16 v[128:129], v251 offset:41056
    s_waitcnt vmcnt(6)
    s_waitcnt lgkmcnt(15)
    v_mfma_f32_16x16x32_bf16 v[184:187], v[76:79], v[220:223], v[184:187]
    buffer_load_dwordx4 v[216:219], v250, s[32:35], s82 offen offset:3072 sc1
    ds_read_b64_tr_b16 v[130:131], v251 offset:43616
    s_waitcnt lgkmcnt(15)
    v_mfma_f32_16x16x32_bf16 v[188:191], v[80:83], v[220:223], v[188:191]
    ds_read_b64_tr_b16 v[132:133], v251 offset:41088
    ds_read_b64_tr_b16 v[134:135], v251 offset:43648
    s_waitcnt lgkmcnt(15)
    v_mfma_f32_16x16x32_bf16 v[192:195], v[84:87], v[220:223], v[192:195]
    ds_read_b64_tr_b16 v[230:231], v251 offset:46080
    s_waitcnt lgkmcnt(15)
    v_mfma_f32_16x16x32_bf16 v[196:199], v[88:91], v[220:223], v[196:199]
    ds_read_b64_tr_b16 v[232:233], v251 offset:48640
    ds_read_b64_tr_b16 v[234:235], v251 offset:46112
    s_waitcnt lgkmcnt(15)
    v_mfma_f32_16x16x32_bf16 v[200:203], v[92:95], v[220:223], v[200:203]
    ds_read_b64_tr_b16 v[236:237], v251 offset:48672
    s_waitcnt vmcnt(6)
    s_waitcnt lgkmcnt(15)
    v_mfma_f32_16x16x32_bf16 v[184:187], v[96:99], v[4:7], v[184:187]
    ds_read_b64_tr_b16 v[238:239], v251 offset:46144
    s_waitcnt lgkmcnt(15)
    v_mfma_f32_16x16x32_bf16 v[188:191], v[100:103], v[4:7], v[188:191]
    ds_read_b64_tr_b16 v[240:241], v251 offset:48704
    ds_read_b64_tr_b16 v[242:243], v251 offset:46176
    s_waitcnt lgkmcnt(15)
    v_mfma_f32_16x16x32_bf16 v[192:195], v[104:107], v[4:7], v[192:195]
    ds_read_b64_tr_b16 v[244:245], v251 offset:48736
    s_waitcnt lgkmcnt(15)
    v_mfma_f32_16x16x32_bf16 v[196:199], v[108:111], v[4:7], v[196:199]
    ds_read_b64_tr_b16 v[246:247], v251 offset:46208
    ds_read_b64_tr_b16 v[248:249], v251 offset:48768
    s_waitcnt lgkmcnt(15)
    v_mfma_f32_16x16x32_bf16 v[200:203], v[112:115], v[4:7], v[200:203]
    ds_read_b64_tr_b16 v[16:17], v251 offset:51200
    s_waitcnt vmcnt(5)
    s_waitcnt lgkmcnt(15)
    v_mfma_f32_16x16x32_bf16 v[184:187], v[144:147], v[8:11], v[184:187]
    ds_read_b64_tr_b16 v[18:19], v251 offset:53760
    s_waitcnt lgkmcnt(15)
    v_mfma_f32_16x16x32_bf16 v[188:191], v[148:151], v[8:11], v[188:191]
    ds_read_b64_tr_b16 v[20:21], v251 offset:51232
    ds_read_b64_tr_b16 v[22:23], v251 offset:53792
    s_waitcnt lgkmcnt(15)
    v_mfma_f32_16x16x32_bf16 v[192:195], v[152:155], v[8:11], v[192:195]
    ds_read_b64_tr_b16 v[24:25], v251 offset:51264
    s_waitcnt lgkmcnt(15)
    v_mfma_f32_16x16x32_bf16 v[196:199], v[156:159], v[8:11], v[196:199]
    ds_read_b64_tr_b16 v[26:27], v251 offset:53824
    ds_read_b64_tr_b16 v[28:29], v251 offset:51296
    s_waitcnt lgkmcnt(15)
    v_mfma_f32_16x16x32_bf16 v[200:203], v[160:163], v[8:11], v[200:203]
    ds_read_b64_tr_b16 v[30:31], v251 offset:53856
    s_waitcnt vmcnt(4)
    s_waitcnt lgkmcnt(15)
    v_mfma_f32_16x16x32_bf16 v[184:187], v[164:167], v[12:15], v[184:187]
    ds_read_b64_tr_b16 v[32:33], v251 offset:51328
    s_waitcnt lgkmcnt(15)
    v_mfma_f32_16x16x32_bf16 v[188:191], v[168:171], v[12:15], v[188:191]
    ds_read_b64_tr_b16 v[34:35], v251 offset:53888
    ds_read_b64_tr_b16 v[36:37], v251 offset:56320
    s_waitcnt lgkmcnt(15)
    v_mfma_f32_16x16x32_bf16 v[192:195], v[172:175], v[12:15], v[192:195]
    ds_read_b64_tr_b16 v[38:39], v251 offset:58880
    s_waitcnt lgkmcnt(15)
    v_mfma_f32_16x16x32_bf16 v[196:199], v[176:179], v[12:15], v[196:199]
    ds_read_b64_tr_b16 v[40:41], v251 offset:56352
    ds_read_b64_tr_b16 v[42:43], v251 offset:58912
    s_waitcnt lgkmcnt(15)
    v_mfma_f32_16x16x32_bf16 v[200:203], v[180:183], v[12:15], v[200:203]
    ds_read_b64_tr_b16 v[44:45], v251 offset:56384
    s_waitcnt vmcnt(3)
    s_waitcnt lgkmcnt(15)
    v_mfma_f32_16x16x32_bf16 v[184:187], v[116:119], v[204:207], v[184:187]
    ds_read_b64_tr_b16 v[46:47], v251 offset:58944
    s_waitcnt lgkmcnt(15)
    v_mfma_f32_16x16x32_bf16 v[188:191], v[120:123], v[204:207], v[188:191]
    ds_read_b64_tr_b16 v[48:49], v251 offset:56416
    ds_read_b64_tr_b16 v[50:51], v251 offset:58976
    s_waitcnt lgkmcnt(15)
    v_mfma_f32_16x16x32_bf16 v[192:195], v[124:127], v[204:207], v[192:195]
    ds_read_b64_tr_b16 v[52:53], v251 offset:56448
    s_waitcnt lgkmcnt(15)
    v_mfma_f32_16x16x32_bf16 v[196:199], v[128:131], v[204:207], v[196:199]
    ds_read_b64_tr_b16 v[54:55], v251 offset:59008
    s_waitcnt lgkmcnt(15)
    v_mfma_f32_16x16x32_bf16 v[200:203], v[132:135], v[204:207], v[200:203]
    s_waitcnt vmcnt(2)
    s_waitcnt lgkmcnt(15)
    v_mfma_f32_16x16x32_bf16 v[184:187], v[230:233], v[208:211], v[184:187]
    s_waitcnt lgkmcnt(15)
    v_mfma_f32_16x16x32_bf16 v[188:191], v[234:237], v[208:211], v[188:191]
    s_waitcnt lgkmcnt(15)
    v_mfma_f32_16x16x32_bf16 v[192:195], v[238:241], v[208:211], v[192:195]
    s_waitcnt lgkmcnt(15)
    v_mfma_f32_16x16x32_bf16 v[196:199], v[242:245], v[208:211], v[196:199]
    s_waitcnt lgkmcnt(15)
    v_mfma_f32_16x16x32_bf16 v[200:203], v[246:249], v[208:211], v[200:203]
    s_waitcnt vmcnt(1)
    s_waitcnt lgkmcnt(15)
    v_mfma_f32_16x16x32_bf16 v[184:187], v[16:19], v[212:215], v[184:187]
    s_waitcnt lgkmcnt(15)
    v_mfma_f32_16x16x32_bf16 v[188:191], v[20:23], v[212:215], v[188:191]
    s_waitcnt lgkmcnt(14)
    v_mfma_f32_16x16x32_bf16 v[192:195], v[24:27], v[212:215], v[192:195]
    s_waitcnt lgkmcnt(12)
    v_mfma_f32_16x16x32_bf16 v[196:199], v[28:31], v[212:215], v[196:199]
    s_waitcnt lgkmcnt(10)
    v_mfma_f32_16x16x32_bf16 v[200:203], v[32:35], v[212:215], v[200:203]
    s_waitcnt vmcnt(0)
    s_waitcnt lgkmcnt(8)
    v_mfma_f32_16x16x32_bf16 v[184:187], v[36:39], v[216:219], v[184:187]
    s_waitcnt lgkmcnt(6)
    v_mfma_f32_16x16x32_bf16 v[188:191], v[40:43], v[216:219], v[188:191]
    s_waitcnt lgkmcnt(4)
    v_mfma_f32_16x16x32_bf16 v[192:195], v[44:47], v[216:219], v[192:195]
    s_waitcnt lgkmcnt(2)
    v_mfma_f32_16x16x32_bf16 v[196:199], v[48:51], v[216:219], v[196:199]
    s_waitcnt lgkmcnt(0)
    v_mfma_f32_16x16x32_bf16 v[200:203], v[52:55], v[216:219], v[200:203]
    v_cvt_pk_bf16_f32 v4, v184, v185
    v_cvt_pk_bf16_f32 v5, v186, v187
    ds_write_b64 v253, v[4:5] offset:0
    v_cvt_pk_bf16_f32 v6, v188, v189
    v_cvt_pk_bf16_f32 v7, v190, v191
    ds_write_b64 v253, v[6:7] offset:32
    v_cvt_pk_bf16_f32 v8, v192, v193
    v_cvt_pk_bf16_f32 v9, v194, v195
    ds_write_b64 v253, v[8:9] offset:64
    v_cvt_pk_bf16_f32 v10, v196, v197
    v_cvt_pk_bf16_f32 v11, v198, v199
    ds_write_b64 v253, v[10:11] offset:96
    v_cvt_pk_bf16_f32 v12, v200, v201
    v_cvt_pk_bf16_f32 v13, v202, v203
    ds_write_b64 v253, v[12:13] offset:128
    ds_read_b128 v[16:19], v224
    ds_read_b128 v[20:23], v225
    ds_read_b128 v[24:27], v226
    s_waitcnt lgkmcnt(2)
    buffer_store_dwordx4 v[16:19], v227, s[36:39], 0 offen sc1
    s_waitcnt lgkmcnt(1)
    buffer_store_dwordx4 v[20:23], v228, s[36:39], 0 offen sc1
    s_waitcnt lgkmcnt(0)
    buffer_store_dwordx4 v[24:27], v229, s[36:39], 0 offen sc1
L_exit:
    s_endpgm
L_last:
    s_endpgm
.section .rodata,"a"
.p2align 6
.amdhsa_kernel concat_heads__sliding_local_dilated__spectral_fnet__prompt_kernel
  .amdhsa_next_free_vgpr 256
  .amdhsa_next_free_sgpr 102
  .amdhsa_accum_offset 256
  .amdhsa_group_segment_fixed_size 0
  .amdhsa_kernarg_size 88
  .amdhsa_user_sgpr_count 2
  .amdhsa_user_sgpr_kernarg_segment_ptr 1
  .amdhsa_system_sgpr_workgroup_id_x 1
  .amdhsa_float_denorm_mode_32 3
.end_amdhsa_kernel
```
